```python
import torch

def _softmax(x, axis=-1):
    return torch.softmax(x, dim=axis)
def _gelu(x):
    return torch.nn.functional.gelu(x, approximate="tanh")
def _silu(x):
    return torch.nn.functional.silu(x)
def _sigmoid(x):
    return torch.sigmoid(x)
def _layernorm(x, axis=-1, eps=1e-5):
    m = x.mean(dim=axis, keepdim=True)
    v = x.var(dim=axis, keepdim=True, unbiased=False)
    return (x - m) / torch.sqrt(v + eps)
def _scatter_add(tgt, idx, src, axis=0):
    return tgt.clone().index_add_(axis, idx, src)
def _segment_sum(src, seg, n):
    out = torch.zeros((n,) + src.shape[1:], dtype=src.dtype)
    return out.index_add_(0, seg, src)
def _pad(x, pw):
    flat = tuple(v for pair in reversed(pw) for v in pair)
    return torch.nn.functional.pad(x, flat)

kernel_name = 'gated_mix__ssm_conv_h3__dense_activation_relu__prompt'

def setup_inputs():

    _w = (lambda a: (lambda t: t.to(torch.bfloat16) if t.is_floating_point() else t)(torch.as_tensor(a)))
    def _A_setup():
        B, S, D = 1, 2048, 512
        ks = 4
        return {
            "q": _w((lambda *s: torch.randn(*s, dtype=torch.bfloat16) * 0.05)(B, S, D)),
            "k": _w((lambda *s: torch.randn(*s, dtype=torch.bfloat16) * 0.8)(B, S, D)),
            "v": _w((lambda *s: torch.randn(*s, dtype=torch.bfloat16) * 0.8)(B, S, D)),
            "shift_k": _w((lambda *s: torch.randn(*s, dtype=torch.bfloat16) * 0.8)(D, ks) * 0.5),
            "ssm_k": _w((lambda *s: torch.randn(*s, dtype=torch.bfloat16) * 0.8)(D, S) * (1.0 / S ** 0.5)),
            "ssm_D": _w((lambda *s: torch.randn(*s, dtype=torch.bfloat16) * 0.8)(D)),
        }
    _A_in = _A_setup()

    def _B_setup():
        B, S, D, Dff = 1, 2048, 512, 1792
        return {
            "x": _w((lambda *s: torch.randn(*s, dtype=torch.bfloat16) * 0.05)(B, S, D)),
            "w1": _w((lambda *s: torch.randn(*s, dtype=torch.bfloat16) * 0.05)(D, Dff)),
            "w2": _w((lambda *s: torch.randn(*s, dtype=torch.bfloat16) * 0.05)(Dff, D)),
        }
    _B_in = _B_setup()

    return {
        "A_q": _A_in["q"],
        "A_k": _A_in["k"],
        "A_v": _A_in["v"],
        "A_shift_k": _A_in["shift_k"],
        "A_ssm_k": _A_in["ssm_k"],
        "A_ssm_D": _A_in["ssm_D"],
        "B_x": _B_in["x"],
        "B_w1": _B_in["w1"],
        "B_w2": _B_in["w2"],
        "gate_w": _w((lambda *s: torch.randn(*s, dtype=torch.bfloat16) * 0.05)(512) * 16.0),
    }

def reference(A_q, A_k, A_v, A_shift_k, A_ssm_k, A_ssm_D, B_x, B_w1, B_w2, gate_w):
    def _A_ref(q, k, v, shift_k, ssm_k, ssm_D):
        B, S, D = q.shape
        ks = shift_k.shape[-1]
        k_pad = _pad(k, ((0, 0), (ks - 1, 0), (0, 0)))
        k_shift = torch.zeros_like(k)
        for t in range(ks):
            k_shift = k_shift + k_pad[:, t:t + S, :] * shift_k[:, ks - 1 - t][None, None, :]
        kv = k_shift * v
        L = 2 * S
        kv_pad = _pad(kv, ((0, 0), (0, S), (0, 0)))
        kf_pad = _pad(ssm_k, ((0, 0), (0, S)))
        kv_f = (lambda x, axes=(-2,-1): torch.fft.rfft2(x.float(), dim=axes))(kv_pad[:, None, :, :], axes=(1, 2))
        kf_f = (lambda x, axes=(-2,-1): torch.fft.rfft2(x.float(), dim=axes))(kf_pad[:, None, :], axes=(1, 2))
        kf_f = (lambda x, *d: x.permute(*d))(kf_f, 1, 2, 0)
        y_f = kv_f * kf_f[None, :, :, :]
        y = (lambda x, s, axes=(-2,-1): torch.fft.irfft2(x, s=s, dim=axes).to(torch.bfloat16))(y_f, (1, L), axes=(1, 2))[:, 0, :S, :]
        y = y + kv * ssm_D[None, None, :]
        return q * y

    def _B_ref(x, w1, w2):
        h = torch.einsum("bsd,df->bsf", x, w1)
        zero = torch.zeros_like(h)
        h = torch.maximum(h, zero)
        return torch.einsum("bsf,fd->bsd", h, w2)

    x = A_q
    g = _sigmoid((x * gate_w).sum(-1, keepdims=True))
    a = _A_ref(x, A_k, A_v, A_shift_k, A_ssm_k, A_ssm_D)
    b = _B_ref(x, B_w1, B_w2)
    return g * a + (1 - g) * b
```

```asm
; @launch kernel=fused_kernel grid=(512,1,1) block=(256,1,1) lds=81920
.amdgcn_target "amdgcn-amd-amdhsa--gfx950"
.text
.globl fused_kernel
.p2align 8
.type fused_kernel,@function
fused_kernel:
    s_cmp_ge_u32 s2, 512
    s_cbranch_scc1 F_END
    v_lshrrev_b32 v1, 6, v0
    v_and_b32 v0, 63, v0
    s_nop 0
    v_readfirstlane_b32 s20, v1
    s_cmp_ge_u32 s2, 256
    s_cbranch_scc1 F_B
    s_load_dwordx2 s[4:5], s[0:1], 0
    s_load_dwordx2 s[14:15], s[0:1], 56
    s_load_dwordx2 s[18:19], s[0:1], 96
    s_load_dwordx4 s[64:67], s[0:1], 64
    s_load_dwordx4 s[68:71], s[0:1], 80
    s_setprio 2
    s_and_b32 s21, s2, 7
    s_lshr_b32 s22, s2, 3
    s_mul_i32 s23, s22, 37
    s_lshr_b32 s23, s23, 8
    s_lshr_b32 s25, s21, 1
    s_lshl_b32 s25, s25, 2
    s_add_u32 s25, s25, s23
    s_mul_i32 s23, s23, 7
    s_sub_u32 s26, s22, s23
    s_and_b32 s23, s21, 1
    s_mul_i32 s23, s23, 7
    s_add_u32 s26, s26, s23
    s_lshl_b32 s48, s21, 2
    s_lshr_b32 s49, s22, 3
    s_add_u32 s48, s48, s49
    s_and_b32 s49, s22, 7
    s_mul_i32 s56, s20, 20480
    s_lshl_b32 s57, s48, 1
    s_mul_i32 s57, s57, 112
    s_mul_i32 s58, s20, 28
    s_add_u32 s57, s57, s58
    s_lshl_b32 s57, s57, 10
    s_add_u32 s58, s57, 114688
    s_waitcnt lgkmcnt(0)
    s_mov_b32 s28, s4
    s_mov_b32 s29, s5
    s_mov_b32 s30, 0x200000
    s_mov_b32 s31, 0x00020000
    s_mov_b32 s32, s14
    s_mov_b32 s33, s15
    s_mov_b32 s34, 0x1c0000
    s_mov_b32 s35, 0x00020000
    s_mov_b32 s72, s64
    s_mov_b32 s73, s65
    s_mov_b32 s74, 0x1c0000
    s_mov_b32 s75, 0x00020000
    s_mov_b32 s76, s18
    s_mov_b32 s77, s19
    s_mov_b32 s78, 0x700000
    s_mov_b32 s79, 0x00020000
    s_add_u32 s80, s18, 0xb00000
    s_addc_u32 s81, s19, 0
    s_mov_b32 s82, 0x200000
    s_mov_b32 s83, 0x00020000
    s_add_u32 s84, s18, 0xa00000
    s_addc_u32 s85, s19, 0
    s_mov_b32 s86, 0x2000
    s_mov_b32 s87, 0x00020000
    s_mov_b32 s88, s4
    s_mov_b32 s89, s5
    s_mov_b32 s90, 0x200000
    s_mov_b32 s91, 0x00020000
    s_mov_b32 s92, s70
    s_mov_b32 s93, s71
    s_mov_b32 s94, 0x100
    s_mov_b32 s95, 0x00020000
    s_mov_b32 s96, s68
    s_mov_b32 s97, s69
    s_mov_b32 s98, 0x200000
    s_mov_b32 s99, 0x00020000
    s_add_u32 s52, s18, 0xf00000
    s_addc_u32 s53, s19, 0
    s_mov_b32 s54, 0x18000
    s_mov_b32 s55, 0x00020000
    v_mov_b32 v1, 0
    s_or_b32 s46, s2, s20
    s_cmp_lg_u32 s46, 0
    s_cbranch_scc1 A_NOPUB
    s_memrealtime s[46:47]
    s_waitcnt lgkmcnt(0)
    s_or_b32 s46, s46, 1
    v_mov_b32 v2, s46
    v_mov_b32 v3, s47
    s_mov_b64 exec, 1
    buffer_store_dwordx2 v[2:3], v1, s[92:95], 0 offen sc1
    s_mov_b64 exec, -1
A_NOPUB:
    v_mov_b32 v1, 0
    buffer_load_dwordx2 v[22:23], v1, s[92:95], 0 offen sc1
    s_mov_b32 s60, s18
    s_mov_b32 s61, s19
    s_mov_b32 s62, 0x1000000
    s_mov_b32 s63, 0x00020000
    v_lshlrev_b32 v1, 20, v0
    buffer_load_dword v24, v1, s[60:63], 0 offen
    buffer_load_dword v24, v1, s[72:75], 0 offen
    buffer_load_dword v24, v1, s[96:99], 0 offen
    s_cmp_ge_u32 s2, 224
    s_cbranch_scc1 A_PRE_I
    v_lshrrev_b32 v2, 3, v0
    s_lshl_b32 s27, s25, 7
    s_lshl_b32 s40, s20, 5
    s_add_u32 s27, s27, s40
    v_add_u32 v2, s27, v2
    v_lshlrev_b32 v2, 10, v2
    v_and_b32 v3, 7, v0
    v_lshrrev_b32 v4, 4, v0
    v_xor_b32 v3, v3, v4
    v_lshl_add_u32 v2, v3, 4, v2
    v_xor_b32 v3, 64, v2
    s_lshl_b32 s40, s20, 3
    v_add_u32 v5, s40, v4
    s_movk_i32 s41, 3584
    v_mul_lo_u32 v5, v5, s41
    v_and_b32 v6, 15, v0
    v_lshlrev_b32 v7, 2, v4
    v_xor_b32 v6, v6, v7
    v_lshl_add_u32 v5, v6, 4, v5
    s_lshl_b32 s40, s26, 8
    v_add_u32 v5, s40, v5
    s_lshl_b32 s42, s20, 12
    s_lshl_b32 s47, s20, 11
    s_and_b32 s51, s26, 7
    s_lshl_b32 s50, s51, 7
    s_lshl_b32 s51, s51, 1
    s_add_u32 m0, s42, 0
    s_add_u32 s43, s50, 0
    s_and_b32 s43, s43, 1023
    s_add_u32 s43, s43, 0
    buffer_load_dwordx4 v2, s[28:31], s43 offen lds
    s_add_u32 m0, s42, 1024
    s_add_u32 s43, s50, 0
    s_and_b32 s43, s43, 1023
    s_add_u32 s43, s43, 8192
    buffer_load_dwordx4 v3, s[28:31], s43 offen lds
    s_add_u32 m0, s42, 2048
    s_add_u32 s43, s50, 0
    s_and_b32 s43, s43, 1023
    s_add_u32 s43, s43, 16384
    buffer_load_dwordx4 v2, s[28:31], s43 offen lds
    s_add_u32 m0, s42, 3072
    s_add_u32 s43, s50, 0
    s_and_b32 s43, s43, 1023
    s_add_u32 s43, s43, 24576
    buffer_load_dwordx4 v3, s[28:31], s43 offen lds
    s_add_u32 s43, s51, 0
    s_and_b32 s43, s43, 15
    s_mul_i32 s43, s43, 114688
    s_add_u32 s43, s43, 0
    buffer_load_dwordx4 v[128:131], v5, s[32:35], s43 offen
    s_add_u32 s43, s51, 0
    s_and_b32 s43, s43, 15
    s_mul_i32 s43, s43, 114688
    s_add_u32 s43, s43, 14336
    buffer_load_dwordx4 v[132:135], v5, s[32:35], s43 offen
    s_add_u32 s43, s51, 1
    s_and_b32 s43, s43, 15
    s_mul_i32 s43, s43, 114688
    s_add_u32 s43, s43, 0
    buffer_load_dwordx4 v[136:139], v5, s[32:35], s43 offen
    s_add_u32 s43, s51, 1
    s_and_b32 s43, s43, 15
    s_mul_i32 s43, s43, 114688
    s_add_u32 s43, s43, 14336
    buffer_load_dwordx4 v[140:143], v5, s[32:35], s43 offen
    s_add_u32 m0, s42, 16384
    s_add_u32 s43, s50, 128
    s_and_b32 s43, s43, 1023
    s_add_u32 s43, s43, 0
    buffer_load_dwordx4 v2, s[28:31], s43 offen lds
    s_add_u32 m0, s42, 17408
    s_add_u32 s43, s50, 128
    s_and_b32 s43, s43, 1023
    s_add_u32 s43, s43, 8192
    buffer_load_dwordx4 v3, s[28:31], s43 offen lds
    s_add_u32 m0, s42, 18432
    s_add_u32 s43, s50, 128
    s_and_b32 s43, s43, 1023
    s_add_u32 s43, s43, 16384
    buffer_load_dwordx4 v2, s[28:31], s43 offen lds
    s_add_u32 m0, s42, 19456
    s_add_u32 s43, s50, 128
    s_and_b32 s43, s43, 1023
    s_add_u32 s43, s43, 24576
    buffer_load_dwordx4 v3, s[28:31], s43 offen lds
    s_add_u32 s43, s51, 2
    s_and_b32 s43, s43, 15
    s_mul_i32 s43, s43, 114688
    s_add_u32 s43, s43, 0
    buffer_load_dwordx4 v[144:147], v5, s[32:35], s43 offen
    s_add_u32 s43, s51, 2
    s_and_b32 s43, s43, 15
    s_mul_i32 s43, s43, 114688
    s_add_u32 s43, s43, 14336
    buffer_load_dwordx4 v[148:151], v5, s[32:35], s43 offen
    s_add_u32 s43, s51, 3
    s_and_b32 s43, s43, 15
    s_mul_i32 s43, s43, 114688
    s_add_u32 s43, s43, 0
    buffer_load_dwordx4 v[152:155], v5, s[32:35], s43 offen
    s_add_u32 s43, s51, 3
    s_and_b32 s43, s43, 15
    s_mul_i32 s43, s43, 114688
    s_add_u32 s43, s43, 14336
    buffer_load_dwordx4 v[156:159], v5, s[32:35], s43 offen
    s_add_u32 m0, s42, 32768
    s_add_u32 s43, s50, 256
    s_and_b32 s43, s43, 1023
    s_add_u32 s43, s43, 0
    buffer_load_dwordx4 v2, s[28:31], s43 offen lds
    s_add_u32 m0, s42, 33792
    s_add_u32 s43, s50, 256
    s_and_b32 s43, s43, 1023
    s_add_u32 s43, s43, 8192
    buffer_load_dwordx4 v3, s[28:31], s43 offen lds
    s_add_u32 m0, s42, 34816
    s_add_u32 s43, s50, 256
    s_and_b32 s43, s43, 1023
    s_add_u32 s43, s43, 16384
    buffer_load_dwordx4 v2, s[28:31], s43 offen lds
    s_add_u32 m0, s42, 35840
    s_add_u32 s43, s50, 256
    s_and_b32 s43, s43, 1023
    s_add_u32 s43, s43, 24576
    buffer_load_dwordx4 v3, s[28:31], s43 offen lds
    s_add_u32 s43, s51, 4
    s_and_b32 s43, s43, 15
    s_mul_i32 s43, s43, 114688
    s_add_u32 s43, s43, 0
    buffer_load_dwordx4 v[160:163], v5, s[32:35], s43 offen
    s_add_u32 s43, s51, 4
    s_and_b32 s43, s43, 15
    s_mul_i32 s43, s43, 114688
    s_add_u32 s43, s43, 14336
    buffer_load_dwordx4 v[164:167], v5, s[32:35], s43 offen
    s_add_u32 s43, s51, 5
    s_and_b32 s43, s43, 15
    s_mul_i32 s43, s43, 114688
    s_add_u32 s43, s43, 0
    buffer_load_dwordx4 v[168:171], v5, s[32:35], s43 offen
    s_add_u32 s43, s51, 5
    s_and_b32 s43, s43, 15
    s_mul_i32 s43, s43, 114688
    s_add_u32 s43, s43, 14336
    buffer_load_dwordx4 v[172:175], v5, s[32:35], s43 offen
    s_add_u32 m0, s42, 49152
    s_add_u32 s43, s50, 384
    s_and_b32 s43, s43, 1023
    s_add_u32 s43, s43, 0
    buffer_load_dwordx4 v2, s[28:31], s43 offen lds
    s_add_u32 m0, s42, 50176
    s_add_u32 s43, s50, 384
    s_and_b32 s43, s43, 1023
    s_add_u32 s43, s43, 8192
    buffer_load_dwordx4 v3, s[28:31], s43 offen lds
    s_add_u32 m0, s42, 51200
    s_add_u32 s43, s50, 384
    s_and_b32 s43, s43, 1023
    s_add_u32 s43, s43, 16384
    buffer_load_dwordx4 v2, s[28:31], s43 offen lds
    s_add_u32 m0, s42, 52224
    s_add_u32 s43, s50, 384
    s_and_b32 s43, s43, 1023
    s_add_u32 s43, s43, 24576
    buffer_load_dwordx4 v3, s[28:31], s43 offen lds
    s_add_u32 s43, s51, 6
    s_and_b32 s43, s43, 15
    s_mul_i32 s43, s43, 114688
    s_add_u32 s43, s43, 0
    buffer_load_dwordx4 v[176:179], v5, s[32:35], s43 offen
    s_add_u32 s43, s51, 6
    s_and_b32 s43, s43, 15
    s_mul_i32 s43, s43, 114688
    s_add_u32 s43, s43, 14336
    buffer_load_dwordx4 v[180:183], v5, s[32:35], s43 offen
    s_add_u32 s43, s51, 7
    s_and_b32 s43, s43, 15
    s_mul_i32 s43, s43, 114688
    s_add_u32 s43, s43, 0
    buffer_load_dwordx4 v[184:187], v5, s[32:35], s43 offen
    s_add_u32 s43, s51, 7
    s_and_b32 s43, s43, 15
    s_mul_i32 s43, s43, 114688
    s_add_u32 s43, s43, 14336
    buffer_load_dwordx4 v[188:191], v5, s[32:35], s43 offen
    s_add_u32 s43, s51, 8
    s_and_b32 s43, s43, 15
    s_mul_i32 s43, s43, 114688
    s_add_u32 s43, s43, 0
    buffer_load_dwordx4 v[192:195], v5, s[32:35], s43 offen
    s_add_u32 s43, s51, 8
    s_and_b32 s43, s43, 15
    s_mul_i32 s43, s43, 114688
    s_add_u32 s43, s43, 14336
    buffer_load_dwordx4 v[196:199], v5, s[32:35], s43 offen
    s_add_u32 s43, s51, 9
    s_and_b32 s43, s43, 15
    s_mul_i32 s43, s43, 114688
    s_add_u32 s43, s43, 0
    buffer_load_dwordx4 v[200:203], v5, s[32:35], s43 offen
    s_add_u32 s43, s51, 9
    s_and_b32 s43, s43, 15
    s_mul_i32 s43, s43, 114688
    s_add_u32 s43, s43, 14336
    buffer_load_dwordx4 v[204:207], v5, s[32:35], s43 offen
    s_add_u32 s43, s51, 10
    s_and_b32 s43, s43, 15
    s_mul_i32 s43, s43, 114688
    s_add_u32 s43, s43, 0
    buffer_load_dwordx4 v[208:211], v5, s[32:35], s43 offen
    s_add_u32 s43, s51, 10
    s_and_b32 s43, s43, 15
    s_mul_i32 s43, s43, 114688
    s_add_u32 s43, s43, 14336
    buffer_load_dwordx4 v[212:215], v5, s[32:35], s43 offen
    s_add_u32 s43, s51, 11
    s_and_b32 s43, s43, 15
    s_mul_i32 s43, s43, 114688
    s_add_u32 s43, s43, 0
    buffer_load_dwordx4 v[216:219], v5, s[32:35], s43 offen
    s_add_u32 s43, s51, 11
    s_and_b32 s43, s43, 15
    s_mul_i32 s43, s43, 114688
    s_add_u32 s43, s43, 14336
    buffer_load_dwordx4 v[220:223], v5, s[32:35], s43 offen
    s_and_b32 s44, s20, 1
    s_lshr_b32 s45, s20, 1
    v_and_b32 v6, 31, v0
    v_lshrrev_b32 v7, 5, v0
    v_bfe_u32 v8, v0, 1, 3
    v_xor_b32 v8, v8, v7
    v_lshlrev_b32 v8, 4, v8
    v_lshl_add_u32 v8, v6, 7, v8
    s_lshl_b32 s46, s44, 13
    v_add_u32 v8, s46, v8
    v_xor_b32 v10, 0, v8
    v_xor_b32 v11, 32, v8
    v_xor_b32 v12, 64, v8
    v_xor_b32 v13, 96, v8
    v_bfe_u32 v6, v0, 2, 2
    v_lshrrev_b32 v7, 5, v0
    v_lshl_add_u32 v7, v7, 3, v6
    v_lshlrev_b32 v7, 8, v7
    v_bfe_u32 v9, v0, 4, 1
    v_lshl_add_u32 v7, v9, 5, v7
    v_and_b32 v9, 3, v0
    v_lshl_add_u32 v7, v9, 3, v7
    v_add_u32 v7, 65536, v7
    s_lshl_b32 s46, s45, 1
    v_xor_b32 v9, s46, v6
    v_lshl_add_u32 v18, v9, 6, v7
    v_xor_b32 v19, 64, v18
    v_lshlrev_b32 v20, 4, v0
    v_add_u32 v20, s47, v20
    v_add_u32 v20, 65536, v20
    v_mov_b32 v64, 0
    v_mov_b32 v65, 0
    v_mov_b32 v66, 0
    v_mov_b32 v67, 0
    v_mov_b32 v68, 0
    v_mov_b32 v69, 0
    v_mov_b32 v70, 0
    v_mov_b32 v71, 0
    v_mov_b32 v72, 0
    v_mov_b32 v73, 0
    v_mov_b32 v74, 0
    v_mov_b32 v75, 0
    v_mov_b32 v76, 0
    v_mov_b32 v77, 0
    v_mov_b32 v78, 0
    v_mov_b32 v79, 0
    v_mov_b32 v80, 0
    v_mov_b32 v81, 0
    v_mov_b32 v82, 0
    v_mov_b32 v83, 0
    v_mov_b32 v84, 0
    v_mov_b32 v85, 0
    v_mov_b32 v86, 0
    v_mov_b32 v87, 0
    v_mov_b32 v88, 0
    v_mov_b32 v89, 0
    v_mov_b32 v90, 0
    v_mov_b32 v91, 0
    v_mov_b32 v92, 0
    v_mov_b32 v93, 0
    v_mov_b32 v94, 0
    v_mov_b32 v95, 0
    v_mov_b32 v96, 0
    v_mov_b32 v97, 0
    v_mov_b32 v98, 0
    v_mov_b32 v99, 0
    v_mov_b32 v100, 0
    v_mov_b32 v101, 0
    v_mov_b32 v102, 0
    v_mov_b32 v103, 0
    v_mov_b32 v104, 0
    v_mov_b32 v105, 0
    v_mov_b32 v106, 0
    v_mov_b32 v107, 0
    v_mov_b32 v108, 0
    v_mov_b32 v109, 0
    v_mov_b32 v110, 0
    v_mov_b32 v111, 0
    v_mov_b32 v112, 0
    v_mov_b32 v113, 0
    v_mov_b32 v114, 0
    v_mov_b32 v115, 0
    v_mov_b32 v116, 0
    v_mov_b32 v117, 0
    v_mov_b32 v118, 0
    v_mov_b32 v119, 0
    v_mov_b32 v120, 0
    v_mov_b32 v121, 0
    v_mov_b32 v122, 0
    v_mov_b32 v123, 0
    v_mov_b32 v124, 0
    v_mov_b32 v125, 0
    v_mov_b32 v126, 0
    v_mov_b32 v127, 0
    s_waitcnt vmcnt(32)
    ds_write_b128 v20, v[128:131] offset:0
    ds_write_b128 v20, v[132:135] offset:1024
    ds_write_b128 v20, v[136:139] offset:8192
    ds_write_b128 v20, v[140:143] offset:9216
    s_waitcnt lgkmcnt(0)
    s_barrier
    ds_read_b64_tr_b16 v[32:33], v18 offset:0
    ds_read_b64_tr_b16 v[34:35], v18 offset:1024
    ds_read_b64_tr_b16 v[36:37], v19 offset:0
    ds_read_b64_tr_b16 v[38:39], v19 offset:1024
    ds_read_b128 v[40:43], v10 offset:0
    ds_read_b128 v[44:47], v10 offset:4096
    ds_read_b64_tr_b16 v[48:49], v18 offset:4096
    ds_read_b64_tr_b16 v[50:51], v18 offset:5120
    ds_read_b64_tr_b16 v[52:53], v19 offset:4096
    ds_read_b64_tr_b16 v[54:55], v19 offset:5120
    ds_read_b128 v[56:59], v11 offset:0
    ds_read_b128 v[60:63], v11 offset:4096
    s_waitcnt lgkmcnt(2)
    s_waitcnt vmcnt(26)
    s_barrier
    v_mfma_f32_32x32x16_bf16 v[64:79], v[32:35], v[40:43], v[64:79]
    ds_write_b128 v20, v[144:147] offset:0
    ds_write_b128 v20, v[148:151] offset:1024
    s_add_u32 s43, s51, 12
    s_and_b32 s43, s43, 15
    s_mul_i32 s43, s43, 114688
    s_add_u32 s43, s43, 0
    buffer_load_dwordx4 v[128:131], v5, s[32:35], s43 offen
    v_mfma_f32_32x32x16_bf16 v[80:95], v[32:35], v[44:47], v[80:95]
    ds_read_b64_tr_b16 v[224:225], v18 offset:8192
    ds_read_b64_tr_b16 v[226:227], v18 offset:9216
    s_add_u32 s43, s51, 12
    s_and_b32 s43, s43, 15
    s_mul_i32 s43, s43, 114688
    s_add_u32 s43, s43, 14336
    buffer_load_dwordx4 v[132:135], v5, s[32:35], s43 offen
    v_mfma_f32_32x32x16_bf16 v[96:111], v[36:39], v[40:43], v[96:111]
    ds_read_b64_tr_b16 v[228:229], v19 offset:8192
    ds_read_b64_tr_b16 v[230:231], v19 offset:9216
    v_mfma_f32_32x32x16_bf16 v[112:127], v[36:39], v[44:47], v[112:127]
    ds_read_b128 v[232:235], v12 offset:0
    ds_read_b128 v[236:239], v12 offset:4096
    s_waitcnt lgkmcnt(8)
    v_mfma_f32_32x32x16_bf16 v[64:79], v[48:51], v[56:59], v[64:79]
    ds_read_b64_tr_b16 v[32:33], v18 offset:12288
    ds_read_b64_tr_b16 v[34:35], v18 offset:13312
    v_mfma_f32_32x32x16_bf16 v[80:95], v[48:51], v[60:63], v[80:95]
    ds_read_b64_tr_b16 v[36:37], v19 offset:12288
    ds_read_b64_tr_b16 v[38:39], v19 offset:13312
    v_mfma_f32_32x32x16_bf16 v[96:111], v[52:55], v[56:59], v[96:111]
    ds_read_b128 v[40:43], v13 offset:0
    ds_read_b128 v[44:47], v13 offset:4096
    v_mfma_f32_32x32x16_bf16 v[112:127], v[52:55], v[60:63], v[112:127]
    s_waitcnt lgkmcnt(2)
    s_waitcnt vmcnt(26)
    s_barrier
    v_mfma_f32_32x32x16_bf16 v[64:79], v[224:227], v[232:235], v[64:79]
    ds_write_b128 v20, v[152:155] offset:8192
    ds_write_b128 v20, v[156:159] offset:9216
    s_add_u32 s43, s51, 13
    s_and_b32 s43, s43, 15
    s_mul_i32 s43, s43, 114688
    s_add_u32 s43, s43, 0
    buffer_load_dwordx4 v[136:139], v5, s[32:35], s43 offen
    v_mfma_f32_32x32x16_bf16 v[80:95], v[224:227], v[236:239], v[80:95]
    ds_read_b64_tr_b16 v[48:49], v18 offset:0
    ds_read_b64_tr_b16 v[50:51], v18 offset:1024
    s_add_u32 s43, s51, 13
    s_and_b32 s43, s43, 15
    s_mul_i32 s43, s43, 114688
    s_add_u32 s43, s43, 14336
    buffer_load_dwordx4 v[140:143], v5, s[32:35], s43 offen
    v_mfma_f32_32x32x16_bf16 v[96:111], v[228:231], v[232:235], v[96:111]
    ds_read_b64_tr_b16 v[52:53], v19 offset:0
    ds_read_b64_tr_b16 v[54:55], v19 offset:1024
    v_mfma_f32_32x32x16_bf16 v[112:127], v[228:231], v[236:239], v[112:127]
    ds_read_b128 v[56:59], v10 offset:16384
    ds_read_b128 v[60:63], v10 offset:20480
    s_waitcnt lgkmcnt(8)
    v_mfma_f32_32x32x16_bf16 v[64:79], v[32:35], v[40:43], v[64:79]
    ds_read_b64_tr_b16 v[224:225], v18 offset:4096
    ds_read_b64_tr_b16 v[226:227], v18 offset:5120
    v_mfma_f32_32x32x16_bf16 v[80:95], v[32:35], v[44:47], v[80:95]
    ds_read_b64_tr_b16 v[228:229], v19 offset:4096
    ds_read_b64_tr_b16 v[230:231], v19 offset:5120
    v_mfma_f32_32x32x16_bf16 v[96:111], v[36:39], v[40:43], v[96:111]
    ds_read_b128 v[232:235], v11 offset:16384
    ds_read_b128 v[236:239], v11 offset:20480
    v_mfma_f32_32x32x16_bf16 v[112:127], v[36:39], v[44:47], v[112:127]
    s_waitcnt lgkmcnt(2)
    s_waitcnt vmcnt(22)
    s_barrier
    v_mfma_f32_32x32x16_bf16 v[64:79], v[48:51], v[56:59], v[64:79]
    ds_write_b128 v20, v[160:163] offset:0
    ds_write_b128 v20, v[164:167] offset:1024
    s_add_u32 s43, s51, 14
    s_and_b32 s43, s43, 15
    s_mul_i32 s43, s43, 114688
    s_add_u32 s43, s43, 0
    buffer_load_dwordx4 v[144:147], v5, s[32:35], s43 offen
    v_mfma_f32_32x32x16_bf16 v[80:95], v[48:51], v[60:63], v[80:95]
    ds_read_b64_tr_b16 v[32:33], v18 offset:8192
    ds_read_b64_tr_b16 v[34:35], v18 offset:9216
    s_add_u32 s43, s51, 14
    s_and_b32 s43, s43, 15
    s_mul_i32 s43, s43, 114688
    s_add_u32 s43, s43, 14336
    buffer_load_dwordx4 v[148:151], v5, s[32:35], s43 offen
    v_mfma_f32_32x32x16_bf16 v[96:111], v[52:55], v[56:59], v[96:111]
    ds_read_b64_tr_b16 v[36:37], v19 offset:8192
    ds_read_b64_tr_b16 v[38:39], v19 offset:9216
    s_add_u32 m0, s42, 0
    s_add_u32 s43, s50, 512
    s_and_b32 s43, s43, 1023
    s_add_u32 s43, s43, 0
    buffer_load_dwordx4 v2, s[28:31], s43 offen lds
    v_mfma_f32_32x32x16_bf16 v[112:127], v[52:55], v[60:63], v[112:127]
    ds_read_b128 v[40:43], v12 offset:16384
    ds_read_b128 v[44:47], v12 offset:20480
    s_add_u32 m0, s42, 1024
    s_add_u32 s43, s50, 512
    s_and_b32 s43, s43, 1023
    s_add_u32 s43, s43, 8192
    buffer_load_dwordx4 v3, s[28:31], s43 offen lds
    s_waitcnt lgkmcnt(8)
    v_mfma_f32_32x32x16_bf16 v[64:79], v[224:227], v[232:235], v[64:79]
    ds_read_b64_tr_b16 v[48:49], v18 offset:12288
    ds_read_b64_tr_b16 v[50:51], v18 offset:13312
    s_add_u32 m0, s42, 2048
    s_add_u32 s43, s50, 512
    s_and_b32 s43, s43, 1023
    s_add_u32 s43, s43, 16384
    buffer_load_dwordx4 v2, s[28:31], s43 offen lds
    v_mfma_f32_32x32x16_bf16 v[80:95], v[224:227], v[236:239], v[80:95]
    ds_read_b64_tr_b16 v[52:53], v19 offset:12288
    ds_read_b64_tr_b16 v[54:55], v19 offset:13312
    s_add_u32 m0, s42, 3072
    s_add_u32 s43, s50, 512
    s_and_b32 s43, s43, 1023
    s_add_u32 s43, s43, 24576
    buffer_load_dwordx4 v3, s[28:31], s43 offen lds
    v_mfma_f32_32x32x16_bf16 v[96:111], v[228:231], v[232:235], v[96:111]
    ds_read_b128 v[56:59], v13 offset:16384
    ds_read_b128 v[60:63], v13 offset:20480
    v_mfma_f32_32x32x16_bf16 v[112:127], v[228:231], v[236:239], v[112:127]
    s_waitcnt lgkmcnt(2)
    s_waitcnt vmcnt(26)
    s_barrier
    v_mfma_f32_32x32x16_bf16 v[64:79], v[32:35], v[40:43], v[64:79]
    ds_write_b128 v20, v[168:171] offset:8192
    ds_write_b128 v20, v[172:175] offset:9216
    s_add_u32 s43, s51, 15
    s_and_b32 s43, s43, 15
    s_mul_i32 s43, s43, 114688
    s_add_u32 s43, s43, 0
    buffer_load_dwordx4 v[152:155], v5, s[32:35], s43 offen
    v_mfma_f32_32x32x16_bf16 v[80:95], v[32:35], v[44:47], v[80:95]
    ds_read_b64_tr_b16 v[224:225], v18 offset:0
    ds_read_b64_tr_b16 v[226:227], v18 offset:1024
    s_add_u32 s43, s51, 15
    s_and_b32 s43, s43, 15
    s_mul_i32 s43, s43, 114688
    s_add_u32 s43, s43, 14336
    buffer_load_dwordx4 v[156:159], v5, s[32:35], s43 offen
    v_mfma_f32_32x32x16_bf16 v[96:111], v[36:39], v[40:43], v[96:111]
    ds_read_b64_tr_b16 v[228:229], v19 offset:0
    ds_read_b64_tr_b16 v[230:231], v19 offset:1024
    v_mfma_f32_32x32x16_bf16 v[112:127], v[36:39], v[44:47], v[112:127]
    ds_read_b128 v[232:235], v10 offset:32768
    ds_read_b128 v[236:239], v10 offset:36864
    s_waitcnt lgkmcnt(8)
    v_mfma_f32_32x32x16_bf16 v[64:79], v[48:51], v[56:59], v[64:79]
    ds_read_b64_tr_b16 v[32:33], v18 offset:4096
    ds_read_b64_tr_b16 v[34:35], v18 offset:5120
    v_mfma_f32_32x32x16_bf16 v[80:95], v[48:51], v[60:63], v[80:95]
    ds_read_b64_tr_b16 v[36:37], v19 offset:4096
    ds_read_b64_tr_b16 v[38:39], v19 offset:5120
    v_mfma_f32_32x32x16_bf16 v[96:111], v[52:55], v[56:59], v[96:111]
    ds_read_b128 v[40:43], v11 offset:32768
    ds_read_b128 v[44:47], v11 offset:36864
    v_mfma_f32_32x32x16_bf16 v[112:127], v[52:55], v[60:63], v[112:127]
    s_waitcnt lgkmcnt(2)
    s_waitcnt vmcnt(22)
    s_barrier
    v_mfma_f32_32x32x16_bf16 v[64:79], v[224:227], v[232:235], v[64:79]
    ds_write_b128 v20, v[176:179] offset:0
    ds_write_b128 v20, v[180:183] offset:1024
    s_add_u32 m0, s42, 16384
    s_add_u32 s43, s50, 640
    s_and_b32 s43, s43, 1023
    s_add_u32 s43, s43, 0
    buffer_load_dwordx4 v2, s[28:31], s43 offen lds
    v_mfma_f32_32x32x16_bf16 v[80:95], v[224:227], v[236:239], v[80:95]
    ds_read_b64_tr_b16 v[48:49], v18 offset:8192
    ds_read_b64_tr_b16 v[50:51], v18 offset:9216
    s_add_u32 m0, s42, 17408
    s_add_u32 s43, s50, 640
    s_and_b32 s43, s43, 1023
    s_add_u32 s43, s43, 8192
    buffer_load_dwordx4 v3, s[28:31], s43 offen lds
    v_mfma_f32_32x32x16_bf16 v[96:111], v[228:231], v[232:235], v[96:111]
    ds_read_b64_tr_b16 v[52:53], v19 offset:8192
    ds_read_b64_tr_b16 v[54:55], v19 offset:9216
    s_add_u32 m0, s42, 18432
    s_add_u32 s43, s50, 640
    s_and_b32 s43, s43, 1023
    s_add_u32 s43, s43, 16384
    buffer_load_dwordx4 v2, s[28:31], s43 offen lds
    v_mfma_f32_32x32x16_bf16 v[112:127], v[228:231], v[236:239], v[112:127]
    ds_read_b128 v[56:59], v12 offset:32768
    ds_read_b128 v[60:63], v12 offset:36864
    s_add_u32 m0, s42, 19456
    s_add_u32 s43, s50, 640
    s_and_b32 s43, s43, 1023
    s_add_u32 s43, s43, 24576
    buffer_load_dwordx4 v3, s[28:31], s43 offen lds
    s_waitcnt lgkmcnt(8)
    v_mfma_f32_32x32x16_bf16 v[64:79], v[32:35], v[40:43], v[64:79]
    ds_read_b64_tr_b16 v[224:225], v18 offset:12288
    ds_read_b64_tr_b16 v[226:227], v18 offset:13312
    v_mfma_f32_32x32x16_bf16 v[80:95], v[32:35], v[44:47], v[80:95]
    ds_read_b64_tr_b16 v[228:229], v19 offset:12288
    ds_read_b64_tr_b16 v[230:231], v19 offset:13312
    v_mfma_f32_32x32x16_bf16 v[96:111], v[36:39], v[40:43], v[96:111]
    ds_read_b128 v[232:235], v13 offset:32768
    ds_read_b128 v[236:239], v13 offset:36864
    v_mfma_f32_32x32x16_bf16 v[112:127], v[36:39], v[44:47], v[112:127]
    s_waitcnt lgkmcnt(2)
    s_waitcnt vmcnt(24)
    s_barrier
    v_mfma_f32_32x32x16_bf16 v[64:79], v[48:51], v[56:59], v[64:79]
    ds_write_b128 v20, v[184:187] offset:8192
    ds_write_b128 v20, v[188:191] offset:9216
    v_mfma_f32_32x32x16_bf16 v[80:95], v[48:51], v[60:63], v[80:95]
    ds_read_b64_tr_b16 v[32:33], v18 offset:0
    ds_read_b64_tr_b16 v[34:35], v18 offset:1024
    v_mfma_f32_32x32x16_bf16 v[96:111], v[52:55], v[56:59], v[96:111]
    ds_read_b64_tr_b16 v[36:37], v19 offset:0
    ds_read_b64_tr_b16 v[38:39], v19 offset:1024
    v_mfma_f32_32x32x16_bf16 v[112:127], v[52:55], v[60:63], v[112:127]
    ds_read_b128 v[40:43], v10 offset:49152
    ds_read_b128 v[44:47], v10 offset:53248
    s_waitcnt lgkmcnt(8)
    v_mfma_f32_32x32x16_bf16 v[64:79], v[224:227], v[232:235], v[64:79]
    ds_read_b64_tr_b16 v[48:49], v18 offset:4096
    ds_read_b64_tr_b16 v[50:51], v18 offset:5120
    v_mfma_f32_32x32x16_bf16 v[80:95], v[224:227], v[236:239], v[80:95]
    ds_read_b64_tr_b16 v[52:53], v19 offset:4096
    ds_read_b64_tr_b16 v[54:55], v19 offset:5120
    v_mfma_f32_32x32x16_bf16 v[96:111], v[228:231], v[232:235], v[96:111]
    ds_read_b128 v[56:59], v11 offset:49152
    ds_read_b128 v[60:63], v11 offset:53248
    v_mfma_f32_32x32x16_bf16 v[112:127], v[228:231], v[236:239], v[112:127]
    s_waitcnt lgkmcnt(2)
    s_waitcnt vmcnt(22)
    s_barrier
    v_mfma_f32_32x32x16_bf16 v[64:79], v[32:35], v[40:43], v[64:79]
    ds_write_b128 v20, v[192:195] offset:0
    ds_write_b128 v20, v[196:199] offset:1024
    s_add_u32 m0, s42, 32768
    s_add_u32 s43, s50, 768
    s_and_b32 s43, s43, 1023
    s_add_u32 s43, s43, 0
    buffer_load_dwordx4 v2, s[28:31], s43 offen lds
    v_mfma_f32_32x32x16_bf16 v[80:95], v[32:35], v[44:47], v[80:95]
    ds_read_b64_tr_b16 v[224:225], v18 offset:8192
    ds_read_b64_tr_b16 v[226:227], v18 offset:9216
    s_add_u32 m0, s42, 33792
    s_add_u32 s43, s50, 768
    s_and_b32 s43, s43, 1023
    s_add_u32 s43, s43, 8192
    buffer_load_dwordx4 v3, s[28:31], s43 offen lds
    v_mfma_f32_32x32x16_bf16 v[96:111], v[36:39], v[40:43], v[96:111]
    ds_read_b64_tr_b16 v[228:229], v19 offset:8192
    ds_read_b64_tr_b16 v[230:231], v19 offset:9216
    s_add_u32 m0, s42, 34816
    s_add_u32 s43, s50, 768
    s_and_b32 s43, s43, 1023
    s_add_u32 s43, s43, 16384
    buffer_load_dwordx4 v2, s[28:31], s43 offen lds
    v_mfma_f32_32x32x16_bf16 v[112:127], v[36:39], v[44:47], v[112:127]
    ds_read_b128 v[232:235], v12 offset:49152
    ds_read_b128 v[236:239], v12 offset:53248
    s_add_u32 m0, s42, 35840
    s_add_u32 s43, s50, 768
    s_and_b32 s43, s43, 1023
    s_add_u32 s43, s43, 24576
    buffer_load_dwordx4 v3, s[28:31], s43 offen lds
    s_waitcnt lgkmcnt(8)
    v_mfma_f32_32x32x16_bf16 v[64:79], v[48:51], v[56:59], v[64:79]
    ds_read_b64_tr_b16 v[32:33], v18 offset:12288
    ds_read_b64_tr_b16 v[34:35], v18 offset:13312
    v_mfma_f32_32x32x16_bf16 v[80:95], v[48:51], v[60:63], v[80:95]
    ds_read_b64_tr_b16 v[36:37], v19 offset:12288
    ds_read_b64_tr_b16 v[38:39], v19 offset:13312
    v_mfma_f32_32x32x16_bf16 v[96:111], v[52:55], v[56:59], v[96:111]
    ds_read_b128 v[40:43], v13 offset:49152
    ds_read_b128 v[44:47], v13 offset:53248
    v_mfma_f32_32x32x16_bf16 v[112:127], v[52:55], v[60:63], v[112:127]
    s_waitcnt lgkmcnt(2)
    s_waitcnt vmcnt(10)
    s_barrier
    v_mfma_f32_32x32x16_bf16 v[64:79], v[224:227], v[232:235], v[64:79]
    ds_write_b128 v20, v[200:203] offset:8192
    ds_write_b128 v20, v[204:207] offset:9216
    v_mfma_f32_32x32x16_bf16 v[80:95], v[224:227], v[236:239], v[80:95]
    ds_read_b64_tr_b16 v[48:49], v18 offset:0
    ds_read_b64_tr_b16 v[50:51], v18 offset:1024
    v_mfma_f32_32x32x16_bf16 v[96:111], v[228:231], v[232:235], v[96:111]
    ds_read_b64_tr_b16 v[52:53], v19 offset:0
    ds_read_b64_tr_b16 v[54:55], v19 offset:1024
    v_mfma_f32_32x32x16_bf16 v[112:127], v[228:231], v[236:239], v[112:127]
    ds_read_b128 v[56:59], v10 offset:0
    ds_read_b128 v[60:63], v10 offset:4096
    s_waitcnt lgkmcnt(8)
    v_mfma_f32_32x32x16_bf16 v[64:79], v[32:35], v[40:43], v[64:79]
    ds_read_b64_tr_b16 v[224:225], v18 offset:4096
    ds_read_b64_tr_b16 v[226:227], v18 offset:5120
    v_mfma_f32_32x32x16_bf16 v[80:95], v[32:35], v[44:47], v[80:95]
    ds_read_b64_tr_b16 v[228:229], v19 offset:4096
    ds_read_b64_tr_b16 v[230:231], v19 offset:5120
    v_mfma_f32_32x32x16_bf16 v[96:111], v[36:39], v[40:43], v[96:111]
    ds_read_b128 v[232:235], v11 offset:0
    ds_read_b128 v[236:239], v11 offset:4096
    v_mfma_f32_32x32x16_bf16 v[112:127], v[36:39], v[44:47], v[112:127]
    s_waitcnt lgkmcnt(2)
    s_waitcnt vmcnt(22)
    s_barrier
    v_mfma_f32_32x32x16_bf16 v[64:79], v[48:51], v[56:59], v[64:79]
    ds_write_b128 v20, v[208:211] offset:0
    ds_write_b128 v20, v[212:215] offset:1024
    s_add_u32 m0, s42, 49152
    s_add_u32 s43, s50, 896
    s_and_b32 s43, s43, 1023
    s_add_u32 s43, s43, 0
    buffer_load_dwordx4 v2, s[28:31], s43 offen lds
    v_mfma_f32_32x32x16_bf16 v[80:95], v[48:51], v[60:63], v[80:95]
    ds_read_b64_tr_b16 v[32:33], v18 offset:8192
    ds_read_b64_tr_b16 v[34:35], v18 offset:9216
    s_add_u32 m0, s42, 50176
    s_add_u32 s43, s50, 896
    s_and_b32 s43, s43, 1023
    s_add_u32 s43, s43, 8192
    buffer_load_dwordx4 v3, s[28:31], s43 offen lds
    v_mfma_f32_32x32x16_bf16 v[96:111], v[52:55], v[56:59], v[96:111]
    ds_read_b64_tr_b16 v[36:37], v19 offset:8192
    ds_read_b64_tr_b16 v[38:39], v19 offset:9216
    s_add_u32 m0, s42, 51200
    s_add_u32 s43, s50, 896
    s_and_b32 s43, s43, 1023
    s_add_u32 s43, s43, 16384
    buffer_load_dwordx4 v2, s[28:31], s43 offen lds
    v_mfma_f32_32x32x16_bf16 v[112:127], v[52:55], v[60:63], v[112:127]
    ds_read_b128 v[40:43], v12 offset:0
    ds_read_b128 v[44:47], v12 offset:4096
    s_add_u32 m0, s42, 52224
    s_add_u32 s43, s50, 896
    s_and_b32 s43, s43, 1023
    s_add_u32 s43, s43, 24576
    buffer_load_dwordx4 v3, s[28:31], s43 offen lds
    s_waitcnt lgkmcnt(8)
    v_mfma_f32_32x32x16_bf16 v[64:79], v[224:227], v[232:235], v[64:79]
    ds_read_b64_tr_b16 v[48:49], v18 offset:12288
    ds_read_b64_tr_b16 v[50:51], v18 offset:13312
    v_mfma_f32_32x32x16_bf16 v[80:95], v[224:227], v[236:239], v[80:95]
    ds_read_b64_tr_b16 v[52:53], v19 offset:12288
    ds_read_b64_tr_b16 v[54:55], v19 offset:13312
    v_mfma_f32_32x32x16_bf16 v[96:111], v[228:231], v[232:235], v[96:111]
    ds_read_b128 v[56:59], v13 offset:0
    ds_read_b128 v[60:63], v13 offset:4096
    v_mfma_f32_32x32x16_bf16 v[112:127], v[228:231], v[236:239], v[112:127]
    s_waitcnt lgkmcnt(2)
    s_waitcnt vmcnt(8)
    s_barrier
    v_mfma_f32_32x32x16_bf16 v[64:79], v[32:35], v[40:43], v[64:79]
    ds_write_b128 v20, v[216:219] offset:8192
    ds_write_b128 v20, v[220:223] offset:9216
    v_mfma_f32_32x32x16_bf16 v[80:95], v[32:35], v[44:47], v[80:95]
    ds_read_b64_tr_b16 v[224:225], v18 offset:0
    ds_read_b64_tr_b16 v[226:227], v18 offset:1024
    v_mfma_f32_32x32x16_bf16 v[96:111], v[36:39], v[40:43], v[96:111]
    ds_read_b64_tr_b16 v[228:229], v19 offset:0
    ds_read_b64_tr_b16 v[230:231], v19 offset:1024
    v_mfma_f32_32x32x16_bf16 v[112:127], v[36:39], v[44:47], v[112:127]
    ds_read_b128 v[232:235], v10 offset:16384
    ds_read_b128 v[236:239], v10 offset:20480
    s_waitcnt lgkmcnt(8)
    v_mfma_f32_32x32x16_bf16 v[64:79], v[48:51], v[56:59], v[64:79]
    ds_read_b64_tr_b16 v[32:33], v18 offset:4096
    ds_read_b64_tr_b16 v[34:35], v18 offset:5120
    v_mfma_f32_32x32x16_bf16 v[80:95], v[48:51], v[60:63], v[80:95]
    ds_read_b64_tr_b16 v[36:37], v19 offset:4096
    ds_read_b64_tr_b16 v[38:39], v19 offset:5120
    v_mfma_f32_32x32x16_bf16 v[96:111], v[52:55], v[56:59], v[96:111]
    ds_read_b128 v[40:43], v11 offset:16384
    ds_read_b128 v[44:47], v11 offset:20480
    v_mfma_f32_32x32x16_bf16 v[112:127], v[52:55], v[60:63], v[112:127]
    s_waitcnt lgkmcnt(2)
    s_waitcnt vmcnt(22)
    s_barrier
    v_mfma_f32_32x32x16_bf16 v[64:79], v[224:227], v[232:235], v[64:79]
    ds_write_b128 v20, v[128:131] offset:0
    ds_write_b128 v20, v[132:135] offset:1024
    v_mfma_f32_32x32x16_bf16 v[80:95], v[224:227], v[236:239], v[80:95]
    ds_read_b64_tr_b16 v[48:49], v18 offset:8192
    ds_read_b64_tr_b16 v[50:51], v18 offset:9216
    v_mfma_f32_32x32x16_bf16 v[96:111], v[228:231], v[232:235], v[96:111]
    ds_read_b64_tr_b16 v[52:53], v19 offset:8192
    ds_read_b64_tr_b16 v[54:55], v19 offset:9216
    v_mfma_f32_32x32x16_bf16 v[112:127], v[228:231], v[236:239], v[112:127]
    ds_read_b128 v[56:59], v12 offset:16384
    ds_read_b128 v[60:63], v12 offset:20480
    s_waitcnt lgkmcnt(8)
    v_mfma_f32_32x32x16_bf16 v[64:79], v[32:35], v[40:43], v[64:79]
    ds_read_b64_tr_b16 v[224:225], v18 offset:12288
    ds_read_b64_tr_b16 v[226:227], v18 offset:13312
    v_mfma_f32_32x32x16_bf16 v[80:95], v[32:35], v[44:47], v[80:95]
    ds_read_b64_tr_b16 v[228:229], v19 offset:12288
    ds_read_b64_tr_b16 v[230:231], v19 offset:13312
    v_mfma_f32_32x32x16_bf16 v[96:111], v[36:39], v[40:43], v[96:111]
    ds_read_b128 v[232:235], v13 offset:16384
    ds_read_b128 v[236:239], v13 offset:20480
    v_mfma_f32_32x32x16_bf16 v[112:127], v[36:39], v[44:47], v[112:127]
    s_waitcnt lgkmcnt(2)
    s_waitcnt vmcnt(4)
    s_barrier
    v_mfma_f32_32x32x16_bf16 v[64:79], v[48:51], v[56:59], v[64:79]
    ds_write_b128 v20, v[136:139] offset:8192
    ds_write_b128 v20, v[140:143] offset:9216
    v_mfma_f32_32x32x16_bf16 v[80:95], v[48:51], v[60:63], v[80:95]
    ds_read_b64_tr_b16 v[32:33], v18 offset:0
    ds_read_b64_tr_b16 v[34:35], v18 offset:1024
    v_mfma_f32_32x32x16_bf16 v[96:111], v[52:55], v[56:59], v[96:111]
    ds_read_b64_tr_b16 v[36:37], v19 offset:0
    ds_read_b64_tr_b16 v[38:39], v19 offset:1024
    v_mfma_f32_32x32x16_bf16 v[112:127], v[52:55], v[60:63], v[112:127]
    ds_read_b128 v[40:43], v10 offset:32768
    ds_read_b128 v[44:47], v10 offset:36864
    s_waitcnt lgkmcnt(8)
    v_mfma_f32_32x32x16_bf16 v[64:79], v[224:227], v[232:235], v[64:79]
    ds_read_b64_tr_b16 v[48:49], v18 offset:4096
    ds_read_b64_tr_b16 v[50:51], v18 offset:5120
    v_mfma_f32_32x32x16_bf16 v[80:95], v[224:227], v[236:239], v[80:95]
    ds_read_b64_tr_b16 v[52:53], v19 offset:4096
    ds_read_b64_tr_b16 v[54:55], v19 offset:5120
    v_mfma_f32_32x32x16_bf16 v[96:111], v[228:231], v[232:235], v[96:111]
    ds_read_b128 v[56:59], v11 offset:32768
    ds_read_b128 v[60:63], v11 offset:36864
    v_mfma_f32_32x32x16_bf16 v[112:127], v[228:231], v[236:239], v[112:127]
    s_waitcnt lgkmcnt(2)
    s_waitcnt vmcnt(18)
    s_barrier
    v_mfma_f32_32x32x16_bf16 v[64:79], v[32:35], v[40:43], v[64:79]
    ds_write_b128 v20, v[144:147] offset:0
    ds_write_b128 v20, v[148:151] offset:1024
    v_mfma_f32_32x32x16_bf16 v[80:95], v[32:35], v[44:47], v[80:95]
    ds_read_b64_tr_b16 v[224:225], v18 offset:8192
    ds_read_b64_tr_b16 v[226:227], v18 offset:9216
    v_mfma_f32_32x32x16_bf16 v[96:111], v[36:39], v[40:43], v[96:111]
    ds_read_b64_tr_b16 v[228:229], v19 offset:8192
    ds_read_b64_tr_b16 v[230:231], v19 offset:9216
    v_mfma_f32_32x32x16_bf16 v[112:127], v[36:39], v[44:47], v[112:127]
    ds_read_b128 v[232:235], v12 offset:32768
    ds_read_b128 v[236:239], v12 offset:36864
    s_waitcnt lgkmcnt(8)
    v_mfma_f32_32x32x16_bf16 v[64:79], v[48:51], v[56:59], v[64:79]
    ds_read_b64_tr_b16 v[32:33], v18 offset:12288
    ds_read_b64_tr_b16 v[34:35], v18 offset:13312
    v_mfma_f32_32x32x16_bf16 v[80:95], v[48:51], v[60:63], v[80:95]
    ds_read_b64_tr_b16 v[36:37], v19 offset:12288
    ds_read_b64_tr_b16 v[38:39], v19 offset:13312
    v_mfma_f32_32x32x16_bf16 v[96:111], v[52:55], v[56:59], v[96:111]
    ds_read_b128 v[40:43], v13 offset:32768
    ds_read_b128 v[44:47], v13 offset:36864
    v_mfma_f32_32x32x16_bf16 v[112:127], v[52:55], v[60:63], v[112:127]
    s_waitcnt lgkmcnt(2)
    s_waitcnt vmcnt(0)
    s_barrier
    v_mfma_f32_32x32x16_bf16 v[64:79], v[224:227], v[232:235], v[64:79]
    ds_write_b128 v20, v[152:155] offset:8192
    ds_write_b128 v20, v[156:159] offset:9216
    v_mfma_f32_32x32x16_bf16 v[80:95], v[224:227], v[236:239], v[80:95]
    ds_read_b64_tr_b16 v[48:49], v18 offset:0
    ds_read_b64_tr_b16 v[50:51], v18 offset:1024
    v_mfma_f32_32x32x16_bf16 v[96:111], v[228:231], v[232:235], v[96:111]
    ds_read_b64_tr_b16 v[52:53], v19 offset:0
    ds_read_b64_tr_b16 v[54:55], v19 offset:1024
    v_mfma_f32_32x32x16_bf16 v[112:127], v[228:231], v[236:239], v[112:127]
    ds_read_b128 v[56:59], v10 offset:49152
    ds_read_b128 v[60:63], v10 offset:53248
    s_waitcnt lgkmcnt(8)
    v_mfma_f32_32x32x16_bf16 v[64:79], v[32:35], v[40:43], v[64:79]
    ds_read_b64_tr_b16 v[224:225], v18 offset:4096
    ds_read_b64_tr_b16 v[226:227], v18 offset:5120
    v_mfma_f32_32x32x16_bf16 v[80:95], v[32:35], v[44:47], v[80:95]
    ds_read_b64_tr_b16 v[228:229], v19 offset:4096
    ds_read_b64_tr_b16 v[230:231], v19 offset:5120
    v_mfma_f32_32x32x16_bf16 v[96:111], v[36:39], v[40:43], v[96:111]
    ds_read_b128 v[232:235], v11 offset:49152
    ds_read_b128 v[236:239], v11 offset:53248
    v_mfma_f32_32x32x16_bf16 v[112:127], v[36:39], v[44:47], v[112:127]
    s_waitcnt lgkmcnt(2)
    s_barrier
    v_mfma_f32_32x32x16_bf16 v[64:79], v[48:51], v[56:59], v[64:79]
    ds_read_b64_tr_b16 v[32:33], v18 offset:8192
    ds_read_b64_tr_b16 v[34:35], v18 offset:9216
    v_mfma_f32_32x32x16_bf16 v[80:95], v[48:51], v[60:63], v[80:95]
    ds_read_b64_tr_b16 v[36:37], v19 offset:8192
    ds_read_b64_tr_b16 v[38:39], v19 offset:9216
    v_mfma_f32_32x32x16_bf16 v[96:111], v[52:55], v[56:59], v[96:111]
    ds_read_b128 v[40:43], v12 offset:49152
    ds_read_b128 v[44:47], v12 offset:53248
    v_mfma_f32_32x32x16_bf16 v[112:127], v[52:55], v[60:63], v[112:127]
    s_waitcnt lgkmcnt(6)
    v_mfma_f32_32x32x16_bf16 v[64:79], v[224:227], v[232:235], v[64:79]
    ds_read_b64_tr_b16 v[48:49], v18 offset:12288
    ds_read_b64_tr_b16 v[50:51], v18 offset:13312
    v_mfma_f32_32x32x16_bf16 v[80:95], v[224:227], v[236:239], v[80:95]
    ds_read_b64_tr_b16 v[52:53], v19 offset:12288
    ds_read_b64_tr_b16 v[54:55], v19 offset:13312
    v_mfma_f32_32x32x16_bf16 v[96:111], v[228:231], v[232:235], v[96:111]
    ds_read_b128 v[56:59], v13 offset:49152
    ds_read_b128 v[60:63], v13 offset:53248
    v_mfma_f32_32x32x16_bf16 v[112:127], v[228:231], v[236:239], v[112:127]
    s_waitcnt lgkmcnt(2)
    s_barrier
    v_mfma_f32_32x32x16_bf16 v[64:79], v[32:35], v[40:43], v[64:79]
    v_mfma_f32_32x32x16_bf16 v[80:95], v[32:35], v[44:47], v[80:95]
    v_mfma_f32_32x32x16_bf16 v[96:111], v[36:39], v[40:43], v[96:111]
    v_mfma_f32_32x32x16_bf16 v[112:127], v[36:39], v[44:47], v[112:127]
    s_waitcnt lgkmcnt(0)
    v_mfma_f32_32x32x16_bf16 v[64:79], v[48:51], v[56:59], v[64:79]
    v_mfma_f32_32x32x16_bf16 v[80:95], v[48:51], v[60:63], v[80:95]
    v_mfma_f32_32x32x16_bf16 v[96:111], v[52:55], v[56:59], v[96:111]
    v_mfma_f32_32x32x16_bf16 v[112:127], v[52:55], v[60:63], v[112:127]
    s_barrier
    v_lshlrev_b32 v209, 4, v0
    s_lshl_b32 s46, s25, 2
    s_lshl_b32 s47, s44, 1
    s_add_u32 s46, s46, s47
    s_mul_i32 s46, s46, 112
    s_lshl_b32 s47, s26, 3
    s_add_u32 s46, s46, s47
    s_lshl_b32 s47, s45, 2
    s_add_u32 s46, s46, s47
    s_lshl_b32 s46, s46, 10
    v_add_u32 v2, s46, v209
    v_add_u32 v3, 112*1024, v2
    v_max_f32 v64, 0, v64
    v_max_f32 v65, 0, v65
    v_max_f32 v66, 0, v66
    v_max_f32 v67, 0, v67
    v_max_f32 v68, 0, v68
    v_max_f32 v69, 0, v69
    v_max_f32 v70, 0, v70
    v_max_f32 v71, 0, v71
    v_cvt_pk_bf16_f32 v32, v64, v65
    v_cvt_pk_bf16_f32 v33, v66, v67
    v_cvt_pk_bf16_f32 v34, v68, v69
    v_cvt_pk_bf16_f32 v35, v70, v71
    s_nop 1
    v_permlane32_swap_b32 v32, v34
    v_permlane32_swap_b32 v33, v35
    buffer_store_dwordx4 v[32:35], v2, s[76:79], 0 offen offset:0 sc1
    v_max_f32 v72, 0, v72
    v_max_f32 v73, 0, v73
    v_max_f32 v74, 0, v74
    v_max_f32 v75, 0, v75
    v_max_f32 v76, 0, v76
    v_max_f32 v77, 0, v77
    v_max_f32 v78, 0, v78
    v_max_f32 v79, 0, v79
    v_cvt_pk_bf16_f32 v36, v72, v73
    v_cvt_pk_bf16_f32 v37, v74, v75
    v_cvt_pk_bf16_f32 v38, v76, v77
    v_cvt_pk_bf16_f32 v39, v78, v79
    s_nop 1
    v_permlane32_swap_b32 v36, v38
    v_permlane32_swap_b32 v37, v39
    buffer_store_dwordx4 v[36:39], v2, s[76:79], 0 offen offset:1024 sc1
    v_max_f32 v80, 0, v80
    v_max_f32 v81, 0, v81
    v_max_f32 v82, 0, v82
    v_max_f32 v83, 0, v83
    v_max_f32 v84, 0, v84
    v_max_f32 v85, 0, v85
    v_max_f32 v86, 0, v86
    v_max_f32 v87, 0, v87
    v_cvt_pk_bf16_f32 v40, v80, v81
    v_cvt_pk_bf16_f32 v41, v82, v83
    v_cvt_pk_bf16_f32 v42, v84, v85
    v_cvt_pk_bf16_f32 v43, v86, v87
    s_nop 1
    v_permlane32_swap_b32 v40, v42
    v_permlane32_swap_b32 v41, v43
    buffer_store_dwordx4 v[40:43], v3, s[76:79], 0 offen offset:0 sc1
    v_max_f32 v88, 0, v88
    v_max_f32 v89, 0, v89
    v_max_f32 v90, 0, v90
    v_max_f32 v91, 0, v91
    v_max_f32 v92, 0, v92
    v_max_f32 v93, 0, v93
    v_max_f32 v94, 0, v94
    v_max_f32 v95, 0, v95
    v_cvt_pk_bf16_f32 v44, v88, v89
    v_cvt_pk_bf16_f32 v45, v90, v91
    v_cvt_pk_bf16_f32 v46, v92, v93
    v_cvt_pk_bf16_f32 v47, v94, v95
    s_nop 1
    v_permlane32_swap_b32 v44, v46
    v_permlane32_swap_b32 v45, v47
    buffer_store_dwordx4 v[44:47], v3, s[76:79], 0 offen offset:1024 sc1
    v_max_f32 v96, 0, v96
    v_max_f32 v97, 0, v97
    v_max_f32 v98, 0, v98
    v_max_f32 v99, 0, v99
    v_max_f32 v100, 0, v100
    v_max_f32 v101, 0, v101
    v_max_f32 v102, 0, v102
    v_max_f32 v103, 0, v103
    v_cvt_pk_bf16_f32 v32, v96, v97
    v_cvt_pk_bf16_f32 v33, v98, v99
    v_cvt_pk_bf16_f32 v34, v100, v101
    v_cvt_pk_bf16_f32 v35, v102, v103
    s_nop 1
    v_permlane32_swap_b32 v32, v34
    v_permlane32_swap_b32 v33, v35
    buffer_store_dwordx4 v[32:35], v2, s[76:79], 0 offen offset:2048 sc1
    v_max_f32 v104, 0, v104
    v_max_f32 v105, 0, v105
    v_max_f32 v106, 0, v106
    v_max_f32 v107, 0, v107
    v_max_f32 v108, 0, v108
    v_max_f32 v109, 0, v109
    v_max_f32 v110, 0, v110
    v_max_f32 v111, 0, v111
    v_cvt_pk_bf16_f32 v36, v104, v105
    v_cvt_pk_bf16_f32 v37, v106, v107
    v_cvt_pk_bf16_f32 v38, v108, v109
    v_cvt_pk_bf16_f32 v39, v110, v111
    s_nop 1
    v_permlane32_swap_b32 v36, v38
    v_permlane32_swap_b32 v37, v39
    buffer_store_dwordx4 v[36:39], v2, s[76:79], 0 offen offset:3072 sc1
    v_max_f32 v112, 0, v112
    v_max_f32 v113, 0, v113
    v_max_f32 v114, 0, v114
    v_max_f32 v115, 0, v115
    v_max_f32 v116, 0, v116
    v_max_f32 v117, 0, v117
    v_max_f32 v118, 0, v118
    v_max_f32 v119, 0, v119
    v_cvt_pk_bf16_f32 v40, v112, v113
    v_cvt_pk_bf16_f32 v41, v114, v115
    v_cvt_pk_bf16_f32 v42, v116, v117
    v_cvt_pk_bf16_f32 v43, v118, v119
    s_nop 1
    v_permlane32_swap_b32 v40, v42
    v_permlane32_swap_b32 v41, v43
    buffer_store_dwordx4 v[40:43], v3, s[76:79], 0 offen offset:2048 sc1
    v_max_f32 v120, 0, v120
    v_max_f32 v121, 0, v121
    v_max_f32 v122, 0, v122
    v_max_f32 v123, 0, v123
    v_max_f32 v124, 0, v124
    v_max_f32 v125, 0, v125
    v_max_f32 v126, 0, v126
    v_max_f32 v127, 0, v127
    v_cvt_pk_bf16_f32 v44, v120, v121
    v_cvt_pk_bf16_f32 v45, v122, v123
    v_cvt_pk_bf16_f32 v46, v124, v125
    v_cvt_pk_bf16_f32 v47, v126, v127
    s_nop 1
    v_permlane32_swap_b32 v44, v46
    v_permlane32_swap_b32 v45, v47
    buffer_store_dwordx4 v[44:47], v3, s[76:79], 0 offen offset:3072 sc1
    s_waitcnt vmcnt(0)
    s_barrier
    s_cmp_lg_u32 s20, 0
    s_cbranch_scc1 A_PRE
    v_mov_b32 v220, v22
    v_mov_b32 v221, v23
    v_readfirstlane_b32 s46, v22
    s_cmp_lg_u32 s46, 0
    s_cbranch_scc1 A_N1_OK
A_N1:
    v_mov_b32 v221, 0
    buffer_load_dwordx2 v[220:221], v221, s[92:95], 0 offen sc1
    s_waitcnt vmcnt(0)
    v_readfirstlane_b32 s46, v220
    s_cmp_lg_u32 s46, 0
    s_cbranch_scc1 A_N1_OK
    s_sleep 4
    s_branch A_N1
A_N1_OK:
    s_lshl_b32 s46, s25, 4
    s_add_u32 s46, s46, s26
    s_lshl_b32 s46, s46, 7
    v_mov_b32 v1, s46
    s_mov_b64 exec, 1
    buffer_store_dwordx2 v[220:221], v1, s[52:55], 0 offen offset:0 sc1
    s_mov_b64 exec, -1
    s_branch A_PRE
A_PRE_I:
    s_waitcnt vmcnt(0)
A_PRE:
    v_lshrrev_b32 v2, 3, v0
    s_mul_i32 s46, s20, 448
    v_add_u32 v2, s46, v2
    v_lshlrev_b32 v2, 10, v2
    v_and_b32 v3, 7, v0
    v_bfe_u32 v4, v0, 4, 1
    v_lshlrev_b32 v4, 2, v4
    v_xor_b32 v3, v3, v4
    v_lshl_add_u32 v2, v3, 4, v2
    s_lshl_b32 s46, s49, 7
    v_add_u32 v208, s46, v2
    v_lshlrev_b32 v209, 4, v0
    s_add_u32 m0, s56, 0
    s_mov_b32 s59, 0
    buffer_load_dwordx4 v208, s[72:75], s59 offen lds
    s_add_u32 m0, s56, 1024
    s_mov_b32 s59, 8192
    buffer_load_dwordx4 v208, s[72:75], s59 offen lds
    s_add_u32 m0, s56, 2048
    s_mov_b32 s59, 16384
    buffer_load_dwordx4 v208, s[72:75], s59 offen lds
    s_add_u32 m0, s56, 3072
    s_mov_b32 s59, 24576
    buffer_load_dwordx4 v208, s[72:75], s59 offen lds
    s_add_u32 m0, s56, 4096
    s_mov_b32 s59, 32768
    buffer_load_dwordx4 v208, s[72:75], s59 offen lds
    s_add_u32 m0, s56, 5120
    s_mov_b32 s59, 40960
    buffer_load_dwordx4 v208, s[72:75], s59 offen lds
    s_add_u32 m0, s56, 6144
    s_mov_b32 s59, 49152
    buffer_load_dwordx4 v208, s[72:75], s59 offen lds
    s_add_u32 m0, s56, 7168
    s_mov_b32 s59, 57344
    buffer_load_dwordx4 v208, s[72:75], s59 offen lds
    s_add_u32 m0, s56, 8192
    s_mov_b32 s59, 65536
    buffer_load_dwordx4 v208, s[72:75], s59 offen lds
    s_add_u32 m0, s56, 9216
    s_mov_b32 s59, 73728
    buffer_load_dwordx4 v208, s[72:75], s59 offen lds
    s_add_u32 m0, s56, 10240
    s_mov_b32 s59, 81920
    buffer_load_dwordx4 v208, s[72:75], s59 offen lds
    s_add_u32 m0, s56, 11264
    s_mov_b32 s59, 90112
    buffer_load_dwordx4 v208, s[72:75], s59 offen lds
    s_add_u32 m0, s56, 12288
    s_mov_b32 s59, 98304
    buffer_load_dwordx4 v208, s[72:75], s59 offen lds
    s_add_u32 m0, s56, 13312
    s_mov_b32 s59, 106496
    buffer_load_dwordx4 v208, s[72:75], s59 offen lds
    s_add_u32 m0, s56, 14336
    s_mov_b32 s59, 114688
    buffer_load_dwordx4 v208, s[72:75], s59 offen lds
    s_add_u32 m0, s56, 15360
    s_mov_b32 s59, 122880
    buffer_load_dwordx4 v208, s[72:75], s59 offen lds
    s_add_u32 m0, s56, 16384
    s_mov_b32 s59, 131072
    buffer_load_dwordx4 v208, s[72:75], s59 offen lds
    s_add_u32 m0, s56, 17408
    s_mov_b32 s59, 139264
    buffer_load_dwordx4 v208, s[72:75], s59 offen lds
    s_add_u32 m0, s56, 18432
    s_mov_b32 s59, 147456
    buffer_load_dwordx4 v208, s[72:75], s59 offen lds
    s_add_u32 m0, s56, 19456
    s_mov_b32 s59, 155648
    buffer_load_dwordx4 v208, s[72:75], s59 offen lds
A_PRE2:
    s_cmp_eq_u32 s20, 0
    s_cselect_b32 s47, s2, 255
    s_cmp_lt_u32 s47, 224
    s_cbranch_scc1 A_N3_OK
    v_mov_b32 v220, v22
    v_mov_b32 v221, v23
    v_readfirstlane_b32 s46, v22
    s_cmp_lg_u32 s46, 0
    s_cbranch_scc1 A_N3_OK
A_N3:
    v_mov_b32 v221, 0
    buffer_load_dwordx2 v[220:221], v221, s[92:95], 0 offen sc1
    s_waitcnt vmcnt(0)
    v_readfirstlane_b32 s46, v220
    s_cmp_lg_u32 s46, 0
    s_cbranch_scc1 A_N3_OK
    s_sleep 4
    s_branch A_N3
A_N3_OK:
A_POLL:
    v_bfe_u32 v6, v0, 2, 2
    v_lshrrev_b32 v7, 5, v0
    v_lshl_add_u32 v7, v7, 3, v6
    v_lshlrev_b32 v7, 7, v7
    v_bfe_u32 v9, v0, 4, 1
    v_lshl_add_u32 v7, v9, 5, v7
    v_and_b32 v9, 3, v0
    v_lshl_add_u32 v7, v9, 3, v7
    v_lshrrev_b32 v9, 1, v6
    v_lshl_add_u32 v8, v9, 6, v7
    v_add_u32 v8, s56, v8
    v_xor_b32 v9, 64, v8
    v_and_b32 v10, 15, v0
    v_lshrrev_b32 v11, 4, v0
    s_lshl_b32 s59, s48, 6
    s_lshl_b32 s60, s20, 4
    s_add_u32 s59, s59, s60
    v_add_u32 v12, s59, v10
    v_lshlrev_b32 v13, 10, v12
    v_lshl_add_u32 v13, v11, 4, v13
    s_lshl_b32 s60, s49, 7
    v_add_u32 v13, s60, v13
    buffer_load_dwordx4 v[212:215], v13, s[88:91], 0 offen
    buffer_load_dwordx4 v[216:219], v13, s[88:91], 0 offen offset:64
    v_lshlrev_b32 v14, 2, v12
    s_waitcnt vmcnt(18)
    ds_read_b64_tr_b16 v[16:17], v8 offset:0
    ds_read_b64_tr_b16 v[18:19], v8 offset:512
    ds_read_b64_tr_b16 v[20:21], v9 offset:0
    ds_read_b64_tr_b16 v[22:23], v9 offset:512
    ds_read_b64_tr_b16 v[24:25], v8 offset:2048
    ds_read_b64_tr_b16 v[26:27], v8 offset:2560
    ds_read_b64_tr_b16 v[28:29], v9 offset:2048
    ds_read_b64_tr_b16 v[30:31], v9 offset:2560
    s_waitcnt lgkmcnt(0)
    s_add_u32 m0, s56, 0
    s_mov_b32 s59, 163840
    buffer_load_dwordx4 v208, s[72:75], s59 offen lds
    s_add_u32 m0, s56, 1024
    s_mov_b32 s59, 172032
    buffer_load_dwordx4 v208, s[72:75], s59 offen lds
    s_add_u32 m0, s56, 2048
    s_mov_b32 s59, 180224
    buffer_load_dwordx4 v208, s[72:75], s59 offen lds
    s_add_u32 m0, s56, 3072
    s_mov_b32 s59, 188416
    buffer_load_dwordx4 v208, s[72:75], s59 offen lds
    s_waitcnt vmcnt(18)
    ds_read_b64_tr_b16 v[32:33], v8 offset:4096
    ds_read_b64_tr_b16 v[34:35], v8 offset:4608
    ds_read_b64_tr_b16 v[36:37], v9 offset:4096
    ds_read_b64_tr_b16 v[38:39], v9 offset:4608
    ds_read_b64_tr_b16 v[40:41], v8 offset:6144
    ds_read_b64_tr_b16 v[42:43], v8 offset:6656
    ds_read_b64_tr_b16 v[44:45], v9 offset:6144
    ds_read_b64_tr_b16 v[46:47], v9 offset:6656
    s_waitcnt lgkmcnt(0)
    s_add_u32 m0, s56, 4096
    s_mov_b32 s59, 196608
    buffer_load_dwordx4 v208, s[72:75], s59 offen lds
    s_add_u32 m0, s56, 5120
    s_mov_b32 s59, 204800
    buffer_load_dwordx4 v208, s[72:75], s59 offen lds
    s_add_u32 m0, s56, 6144
    s_mov_b32 s59, 212992
    buffer_load_dwordx4 v208, s[72:75], s59 offen lds
    s_add_u32 m0, s56, 7168
    s_mov_b32 s59, 221184
    buffer_load_dwordx4 v208, s[72:75], s59 offen lds
    s_waitcnt vmcnt(18)
    ds_read_b64_tr_b16 v[48:49], v8 offset:8192
    ds_read_b64_tr_b16 v[50:51], v8 offset:8704
    ds_read_b64_tr_b16 v[52:53], v9 offset:8192
    ds_read_b64_tr_b16 v[54:55], v9 offset:8704
    ds_read_b64_tr_b16 v[56:57], v8 offset:10240
    ds_read_b64_tr_b16 v[58:59], v8 offset:10752
    ds_read_b64_tr_b16 v[60:61], v9 offset:10240
    ds_read_b64_tr_b16 v[62:63], v9 offset:10752
    s_waitcnt lgkmcnt(0)
    s_add_u32 m0, s56, 8192
    s_mov_b32 s59, 229376
    buffer_load_dwordx4 v208, s[72:75], s59 offen lds
    s_add_u32 m0, s56, 9216
    s_mov_b32 s59, 237568
    buffer_load_dwordx4 v208, s[72:75], s59 offen lds
    s_add_u32 m0, s56, 10240
    s_mov_b32 s59, 245760
    buffer_load_dwordx4 v208, s[72:75], s59 offen lds
    s_add_u32 m0, s56, 11264
    s_mov_b32 s59, 253952
    buffer_load_dwordx4 v208, s[72:75], s59 offen lds
    s_waitcnt vmcnt(18)
    ds_read_b64_tr_b16 v[128:129], v8 offset:12288
    ds_read_b64_tr_b16 v[130:131], v8 offset:12800
    ds_read_b64_tr_b16 v[132:133], v9 offset:12288
    ds_read_b64_tr_b16 v[134:135], v9 offset:12800
    ds_read_b64_tr_b16 v[136:137], v8 offset:14336
    ds_read_b64_tr_b16 v[138:139], v8 offset:14848
    ds_read_b64_tr_b16 v[140:141], v9 offset:14336
    ds_read_b64_tr_b16 v[142:143], v9 offset:14848
    s_waitcnt lgkmcnt(0)
    s_add_u32 m0, s56, 12288
    s_mov_b32 s59, 262144
    buffer_load_dwordx4 v208, s[72:75], s59 offen lds
    s_add_u32 m0, s56, 13312
    s_mov_b32 s59, 270336
    buffer_load_dwordx4 v208, s[72:75], s59 offen lds
    s_add_u32 m0, s56, 14336
    s_mov_b32 s59, 278528
    buffer_load_dwordx4 v208, s[72:75], s59 offen lds
    s_add_u32 m0, s56, 15360
    s_mov_b32 s59, 286720
    buffer_load_dwordx4 v208, s[72:75], s59 offen lds
    s_waitcnt vmcnt(18)
    ds_read_b64_tr_b16 v[144:145], v8 offset:16384
    ds_read_b64_tr_b16 v[146:147], v8 offset:16896
    ds_read_b64_tr_b16 v[148:149], v9 offset:16384
    ds_read_b64_tr_b16 v[150:151], v9 offset:16896
    ds_read_b64_tr_b16 v[152:153], v8 offset:18432
    ds_read_b64_tr_b16 v[154:155], v8 offset:18944
    ds_read_b64_tr_b16 v[156:157], v9 offset:18432
    ds_read_b64_tr_b16 v[158:159], v9 offset:18944
    s_waitcnt lgkmcnt(0)
    s_add_u32 m0, s56, 16384
    s_mov_b32 s59, 294912
    buffer_load_dwordx4 v208, s[72:75], s59 offen lds
    s_add_u32 m0, s56, 17408
    s_mov_b32 s59, 303104
    buffer_load_dwordx4 v208, s[72:75], s59 offen lds
    s_add_u32 m0, s56, 18432
    s_mov_b32 s59, 311296
    buffer_load_dwordx4 v208, s[72:75], s59 offen lds
    s_add_u32 m0, s56, 19456
    s_mov_b32 s59, 319488
    buffer_load_dwordx4 v208, s[72:75], s59 offen lds
    s_waitcnt vmcnt(16)
    ds_read_b64_tr_b16 v[160:161], v8 offset:0
    ds_read_b64_tr_b16 v[162:163], v8 offset:512
    ds_read_b64_tr_b16 v[164:165], v9 offset:0
    ds_read_b64_tr_b16 v[166:167], v9 offset:512
    ds_read_b64_tr_b16 v[168:169], v8 offset:2048
    ds_read_b64_tr_b16 v[170:171], v8 offset:2560
    ds_read_b64_tr_b16 v[172:173], v9 offset:2048
    ds_read_b64_tr_b16 v[174:175], v9 offset:2560
    s_waitcnt lgkmcnt(0)
    s_add_u32 m0, s56, 0
    s_mov_b32 s59, 327680
    buffer_load_dwordx4 v208, s[72:75], s59 offen lds
    s_add_u32 m0, s56, 1024
    s_mov_b32 s59, 335872
    buffer_load_dwordx4 v208, s[72:75], s59 offen lds
    s_add_u32 m0, s56, 2048
    s_mov_b32 s59, 344064
    buffer_load_dwordx4 v208, s[72:75], s59 offen lds
    s_add_u32 m0, s56, 3072
    s_mov_b32 s59, 352256
    buffer_load_dwordx4 v208, s[72:75], s59 offen lds
    s_lshr_b32 s60, s48, 1
    s_lshl_b32 s60, s60, 4
    s_mul_i32 s61, s20, 7
    s_lshr_b32 s61, s61, 1
    s_add_u32 s60, s60, s61
    v_min_u32 v6, 3, v0
    v_add_u32 v6, s60, v6
    v_lshlrev_b32 v6, 7, v6
A_HP:
    buffer_load_dwordx2 v[222:223], v6, s[52:55], 0 offen offset:0 sc1
    s_waitcnt vmcnt(0)
    v_cmp_ne_u32 vcc, v222, v220
    v_cmp_ne_u32 s[60:61], v223, v221
    s_nop 1
    s_or_b64 vcc, vcc, s[60:61]
    s_cmp_eq_u64 vcc, 0
    s_cbranch_scc1 A_HG
    s_sleep 8
    s_branch A_HP
A_HG:
    s_waitcnt vmcnt(0)
A_HG2:
    s_add_u32 s60, s57, 0
    buffer_load_dwordx4 v[176:179], v209, s[76:79], s60 offen offset:0
    s_add_u32 s60, s58, 0
    buffer_load_dwordx4 v[180:183], v209, s[76:79], s60 offen offset:0
    s_add_u32 s60, s57, 0
    buffer_load_dwordx4 v[184:187], v209, s[76:79], s60 offen offset:1024
    s_add_u32 s60, s58, 0
    buffer_load_dwordx4 v[188:191], v209, s[76:79], s60 offen offset:1024
    s_add_u32 s60, s57, 2048
    buffer_load_dwordx4 v[192:195], v209, s[76:79], s60 offen offset:0
    s_add_u32 s60, s58, 2048
    buffer_load_dwordx4 v[196:199], v209, s[76:79], s60 offen offset:0
    s_add_u32 s60, s57, 2048
    buffer_load_dwordx4 v[200:203], v209, s[76:79], s60 offen offset:1024
    s_add_u32 s60, s58, 2048
    buffer_load_dwordx4 v[204:207], v209, s[76:79], s60 offen offset:1024
    s_add_u32 s60, s57, 4096
    buffer_load_dwordx4 v[224:227], v209, s[76:79], s60 offen offset:0
    s_add_u32 s60, s58, 4096
    buffer_load_dwordx4 v[228:231], v209, s[76:79], s60 offen offset:0
    s_add_u32 s60, s57, 4096
    buffer_load_dwordx4 v[232:235], v209, s[76:79], s60 offen offset:1024
    s_add_u32 s60, s58, 4096
    buffer_load_dwordx4 v[236:239], v209, s[76:79], s60 offen offset:1024
    s_add_u32 s60, s57, 6144
    buffer_load_dwordx4 v[240:243], v209, s[76:79], s60 offen offset:0
    s_add_u32 s60, s58, 6144
    buffer_load_dwordx4 v[244:247], v209, s[76:79], s60 offen offset:0
    s_add_u32 s60, s57, 6144
    buffer_load_dwordx4 v[248:251], v209, s[76:79], s60 offen offset:1024
    s_add_u32 s60, s58, 6144
    buffer_load_dwordx4 v[252:255], v209, s[76:79], s60 offen offset:1024
    v_mov_b32 v64, 0
    v_mov_b32 v65, 0
    v_mov_b32 v66, 0
    v_mov_b32 v67, 0
    v_mov_b32 v68, 0
    v_mov_b32 v69, 0
    v_mov_b32 v70, 0
    v_mov_b32 v71, 0
    v_mov_b32 v72, 0
    v_mov_b32 v73, 0
    v_mov_b32 v74, 0
    v_mov_b32 v75, 0
    v_mov_b32 v76, 0
    v_mov_b32 v77, 0
    v_mov_b32 v78, 0
    v_mov_b32 v79, 0
    v_mov_b32 v80, 0
    v_mov_b32 v81, 0
    v_mov_b32 v82, 0
    v_mov_b32 v83, 0
    v_mov_b32 v84, 0
    v_mov_b32 v85, 0
    v_mov_b32 v86, 0
    v_mov_b32 v87, 0
    v_mov_b32 v88, 0
    v_mov_b32 v89, 0
    v_mov_b32 v90, 0
    v_mov_b32 v91, 0
    v_mov_b32 v92, 0
    v_mov_b32 v93, 0
    v_mov_b32 v94, 0
    v_mov_b32 v95, 0
    v_mov_b32 v96, 0
    v_mov_b32 v97, 0
    v_mov_b32 v98, 0
    v_mov_b32 v99, 0
    v_mov_b32 v100, 0
    v_mov_b32 v101, 0
    v_mov_b32 v102, 0
    v_mov_b32 v103, 0
    v_mov_b32 v104, 0
    v_mov_b32 v105, 0
    v_mov_b32 v106, 0
    v_mov_b32 v107, 0
    v_mov_b32 v108, 0
    v_mov_b32 v109, 0
    v_mov_b32 v110, 0
    v_mov_b32 v111, 0
    v_mov_b32 v112, 0
    v_mov_b32 v113, 0
    v_mov_b32 v114, 0
    v_mov_b32 v115, 0
    v_mov_b32 v116, 0
    v_mov_b32 v117, 0
    v_mov_b32 v118, 0
    v_mov_b32 v119, 0
    v_mov_b32 v120, 0
    v_mov_b32 v121, 0
    v_mov_b32 v122, 0
    v_mov_b32 v123, 0
    v_mov_b32 v124, 0
    v_mov_b32 v125, 0
    v_mov_b32 v126, 0
    v_mov_b32 v127, 0
    s_lshl_b32 s60, s49, 5
    v_add_u32 v6, s60, v0
    v_lshlrev_b32 v6, 7, v6
    v_add_u32 v6, 65536, v6
    v_and_b32 v7, 7, v0
    v_lshlrev_b32 v7, 5, v7
    v_add_u32 v7, s48, v7
    v_lshlrev_b32 v7, 7, v7
    v_add_u32 v7, 65536, v7
    v_cmp_gt_u32 vcc, 32, v0
    v_cndmask_b32 v6, v7, v6, vcc
    s_lshl_b32 s60, s49, 6
    v_lshl_add_u32 v7, v11, 3, s60
    v_lshlrev_b32 v7, 12, v7
    v_lshl_add_u32 v7, v12, 1, v7
    s_waitcnt vmcnt(12) lgkmcnt(0)
    v_mfma_f32_32x32x16_bf16 v[64:79], v[16:19], v[176:179], v[64:79]
    v_mfma_f32_32x32x16_bf16 v[80:95], v[16:19], v[180:183], v[80:95]
    v_mfma_f32_32x32x16_bf16 v[96:111], v[20:23], v[176:179], v[96:111]
    v_mfma_f32_32x32x16_bf16 v[112:127], v[20:23], v[180:183], v[112:127]
    v_mfma_f32_32x32x16_bf16 v[64:79], v[24:27], v[184:187], v[64:79]
    v_mfma_f32_32x32x16_bf16 v[80:95], v[24:27], v[188:191], v[80:95]
    v_mfma_f32_32x32x16_bf16 v[96:111], v[28:31], v[184:187], v[96:111]
    v_mfma_f32_32x32x16_bf16 v[112:127], v[28:31], v[188:191], v[112:127]
    s_waitcnt vmcnt(8) lgkmcnt(0)
    v_mfma_f32_32x32x16_bf16 v[64:79], v[32:35], v[192:195], v[64:79]
    s_add_u32 s60, s57, 8192
    buffer_load_dwordx4 v[16:19], v209, s[76:79], s60 offen offset:0
    s_add_u32 s60, s58, 8192
    buffer_load_dwordx4 v[20:23], v209, s[76:79], s60 offen offset:0
    v_mfma_f32_32x32x16_bf16 v[80:95], v[32:35], v[196:199], v[80:95]
    s_add_u32 s60, s57, 8192
    buffer_load_dwordx4 v[24:27], v209, s[76:79], s60 offen offset:1024
    s_add_u32 s60, s58, 8192
    buffer_load_dwordx4 v[28:31], v209, s[76:79], s60 offen offset:1024
    v_mfma_f32_32x32x16_bf16 v[96:111], v[36:39], v[192:195], v[96:111]
    s_add_u32 s60, s57, 10240
    buffer_load_dwordx4 v[176:179], v209, s[76:79], s60 offen offset:0
    s_add_u32 s60, s58, 10240
    buffer_load_dwordx4 v[180:183], v209, s[76:79], s60 offen offset:0
    v_mfma_f32_32x32x16_bf16 v[112:127], v[36:39], v[196:199], v[112:127]
    s_add_u32 s60, s57, 10240
    buffer_load_dwordx4 v[184:187], v209, s[76:79], s60 offen offset:1024
    s_add_u32 s60, s58, 10240
    buffer_load_dwordx4 v[188:191], v209, s[76:79], s60 offen offset:1024
    v_mfma_f32_32x32x16_bf16 v[64:79], v[40:43], v[200:203], v[64:79]
    v_mfma_f32_32x32x16_bf16 v[80:95], v[40:43], v[204:207], v[80:95]
    v_mfma_f32_32x32x16_bf16 v[96:111], v[44:47], v[200:203], v[96:111]
    v_mfma_f32_32x32x16_bf16 v[112:127], v[44:47], v[204:207], v[112:127]
    s_waitcnt vmcnt(12) lgkmcnt(0)
    v_mfma_f32_32x32x16_bf16 v[64:79], v[48:51], v[224:227], v[64:79]
    s_add_u32 s60, s57, 12288
    buffer_load_dwordx4 v[32:35], v209, s[76:79], s60 offen offset:0
    s_add_u32 s60, s58, 12288
    buffer_load_dwordx4 v[36:39], v209, s[76:79], s60 offen offset:0
    v_mfma_f32_32x32x16_bf16 v[80:95], v[48:51], v[228:231], v[80:95]
    s_add_u32 s60, s57, 12288
    buffer_load_dwordx4 v[40:43], v209, s[76:79], s60 offen offset:1024
    s_add_u32 s60, s58, 12288
    buffer_load_dwordx4 v[44:47], v209, s[76:79], s60 offen offset:1024
    v_mfma_f32_32x32x16_bf16 v[96:111], v[52:55], v[224:227], v[96:111]
    s_add_u32 s60, s57, 14336
    buffer_load_dwordx4 v[192:195], v209, s[76:79], s60 offen offset:0
    s_add_u32 s60, s58, 14336
    buffer_load_dwordx4 v[196:199], v209, s[76:79], s60 offen offset:0
    v_mfma_f32_32x32x16_bf16 v[112:127], v[52:55], v[228:231], v[112:127]
    s_add_u32 s60, s57, 14336
    buffer_load_dwordx4 v[200:203], v209, s[76:79], s60 offen offset:1024
    s_add_u32 s60, s58, 14336
    buffer_load_dwordx4 v[204:207], v209, s[76:79], s60 offen offset:1024
    v_mfma_f32_32x32x16_bf16 v[64:79], v[56:59], v[232:235], v[64:79]
    v_mfma_f32_32x32x16_bf16 v[80:95], v[56:59], v[236:239], v[80:95]
    v_mfma_f32_32x32x16_bf16 v[96:111], v[60:63], v[232:235], v[96:111]
    v_mfma_f32_32x32x16_bf16 v[112:127], v[60:63], v[236:239], v[112:127]
    s_waitcnt vmcnt(16) lgkmcnt(0)
    v_mfma_f32_32x32x16_bf16 v[64:79], v[128:131], v[240:243], v[64:79]
    s_add_u32 s60, s57, 16384
    buffer_load_dwordx4 v[48:51], v209, s[76:79], s60 offen offset:0
    s_add_u32 s60, s58, 16384
    buffer_load_dwordx4 v[52:55], v209, s[76:79], s60 offen offset:0
    v_mfma_f32_32x32x16_bf16 v[80:95], v[128:131], v[244:247], v[80:95]
    s_add_u32 s60, s57, 16384
    buffer_load_dwordx4 v[56:59], v209, s[76:79], s60 offen offset:1024
    s_add_u32 s60, s58, 16384
    buffer_load_dwordx4 v[60:63], v209, s[76:79], s60 offen offset:1024
    v_mfma_f32_32x32x16_bf16 v[96:111], v[132:135], v[240:243], v[96:111]
    s_add_u32 s60, s57, 18432
    buffer_load_dwordx4 v[224:227], v209, s[76:79], s60 offen offset:0
    s_add_u32 s60, s58, 18432
    buffer_load_dwordx4 v[228:231], v209, s[76:79], s60 offen offset:0
    v_mfma_f32_32x32x16_bf16 v[112:127], v[132:135], v[244:247], v[112:127]
    s_add_u32 s60, s57, 18432
    buffer_load_dwordx4 v[232:235], v209, s[76:79], s60 offen offset:1024
    s_add_u32 s60, s58, 18432
    buffer_load_dwordx4 v[236:239], v209, s[76:79], s60 offen offset:1024
    v_mfma_f32_32x32x16_bf16 v[64:79], v[136:139], v[248:251], v[64:79]
    v_mfma_f32_32x32x16_bf16 v[80:95], v[136:139], v[252:255], v[80:95]
    v_mfma_f32_32x32x16_bf16 v[96:111], v[140:143], v[248:251], v[96:111]
    v_mfma_f32_32x32x16_bf16 v[112:127], v[140:143], v[252:255], v[112:127]
    s_waitcnt vmcnt(20) lgkmcnt(0)
    v_mfma_f32_32x32x16_bf16 v[64:79], v[144:147], v[16:19], v[64:79]
    s_add_u32 s60, s57, 20480
    buffer_load_dwordx4 v[128:131], v209, s[76:79], s60 offen offset:0
    s_add_u32 s60, s58, 20480
    buffer_load_dwordx4 v[132:135], v209, s[76:79], s60 offen offset:0
    v_mfma_f32_32x32x16_bf16 v[80:95], v[144:147], v[20:23], v[80:95]
    s_add_u32 s60, s57, 20480
    buffer_load_dwordx4 v[136:139], v209, s[76:79], s60 offen offset:1024
    s_add_u32 s60, s58, 20480
    buffer_load_dwordx4 v[140:143], v209, s[76:79], s60 offen offset:1024
    v_mfma_f32_32x32x16_bf16 v[96:111], v[148:151], v[16:19], v[96:111]
    s_add_u32 s60, s57, 22528
    buffer_load_dwordx4 v[240:243], v209, s[76:79], s60 offen offset:0
    s_add_u32 s60, s58, 22528
    buffer_load_dwordx4 v[244:247], v209, s[76:79], s60 offen offset:0
    v_mfma_f32_32x32x16_bf16 v[112:127], v[148:151], v[20:23], v[112:127]
    s_add_u32 s60, s57, 22528
    buffer_load_dwordx4 v[248:251], v209, s[76:79], s60 offen offset:1024
    s_add_u32 s60, s58, 22528
    buffer_load_dwordx4 v[252:255], v209, s[76:79], s60 offen offset:1024
    v_mfma_f32_32x32x16_bf16 v[64:79], v[152:155], v[24:27], v[64:79]
    v_mfma_f32_32x32x16_bf16 v[80:95], v[152:155], v[28:31], v[80:95]
    v_mfma_f32_32x32x16_bf16 v[96:111], v[156:159], v[24:27], v[96:111]
    v_mfma_f32_32x32x16_bf16 v[112:127], v[156:159], v[28:31], v[112:127]
    s_waitcnt vmcnt(24) lgkmcnt(0)
    v_mfma_f32_32x32x16_bf16 v[64:79], v[160:163], v[176:179], v[64:79]
    ds_read_b64_tr_b16 v[144:145], v8 offset:4096
    ds_read_b64_tr_b16 v[146:147], v8 offset:4608
    s_add_u32 s60, s57, 24576
    buffer_load_dwordx4 v[16:19], v209, s[76:79], s60 offen offset:0
    s_add_u32 s60, s58, 24576
    buffer_load_dwordx4 v[20:23], v209, s[76:79], s60 offen offset:0
    v_mfma_f32_32x32x16_bf16 v[80:95], v[160:163], v[180:183], v[80:95]
    ds_read_b64_tr_b16 v[148:149], v9 offset:4096
    ds_read_b64_tr_b16 v[150:151], v9 offset:4608
    s_add_u32 s60, s57, 24576
    buffer_load_dwordx4 v[24:27], v209, s[76:79], s60 offen offset:1024
    s_add_u32 s60, s58, 24576
    buffer_load_dwordx4 v[28:31], v209, s[76:79], s60 offen offset:1024
    v_mfma_f32_32x32x16_bf16 v[96:111], v[164:167], v[176:179], v[96:111]
    ds_read_b64_tr_b16 v[152:153], v8 offset:6144
    ds_read_b64_tr_b16 v[154:155], v8 offset:6656
    v_mfma_f32_32x32x16_bf16 v[112:127], v[164:167], v[180:183], v[112:127]
    ds_read_b64_tr_b16 v[156:157], v9 offset:6144
    ds_read_b64_tr_b16 v[158:159], v9 offset:6656
    v_mfma_f32_32x32x16_bf16 v[64:79], v[168:171], v[184:187], v[64:79]
    v_mfma_f32_32x32x16_bf16 v[80:95], v[168:171], v[188:191], v[80:95]
    v_mfma_f32_32x32x16_bf16 v[96:111], v[172:175], v[184:187], v[96:111]
    v_mfma_f32_32x32x16_bf16 v[112:127], v[172:175], v[188:191], v[112:127]
    s_waitcnt vmcnt(24) lgkmcnt(0)
    v_mfma_f32_32x32x16_bf16 v[64:79], v[144:147], v[32:35], v[64:79]
    ds_read_b64_tr_b16 v[160:161], v8 offset:8192
    ds_read_b64_tr_b16 v[162:163], v8 offset:8704
    s_add_u32 s60, s57, 26624
    buffer_load_dwordx4 v[176:179], v209, s[76:79], s60 offen offset:0
    s_add_u32 s60, s58, 26624
    buffer_load_dwordx4 v[180:183], v209, s[76:79], s60 offen offset:0
    v_mfma_f32_32x32x16_bf16 v[80:95], v[144:147], v[36:39], v[80:95]
    ds_read_b64_tr_b16 v[164:165], v9 offset:8192
    ds_read_b64_tr_b16 v[166:167], v9 offset:8704
    s_add_u32 s60, s57, 26624
    buffer_load_dwordx4 v[184:187], v209, s[76:79], s60 offen offset:1024
    s_add_u32 s60, s58, 26624
    buffer_load_dwordx4 v[188:191], v209, s[76:79], s60 offen offset:1024
    v_mfma_f32_32x32x16_bf16 v[96:111], v[148:151], v[32:35], v[96:111]
    ds_read_b64_tr_b16 v[168:169], v8 offset:10240
    ds_read_b64_tr_b16 v[170:171], v8 offset:10752
    s_add_u32 m0, s56, 4096
    s_mov_b32 s59, 360448
    buffer_load_dwordx4 v208, s[72:75], s59 offen lds
    s_add_u32 m0, s56, 5120
    s_mov_b32 s59, 368640
    buffer_load_dwordx4 v208, s[72:75], s59 offen lds
    v_mfma_f32_32x32x16_bf16 v[112:127], v[148:151], v[36:39], v[112:127]
    ds_read_b64_tr_b16 v[172:173], v9 offset:10240
    ds_read_b64_tr_b16 v[174:175], v9 offset:10752
    s_add_u32 m0, s56, 6144
    s_mov_b32 s59, 376832
    buffer_load_dwordx4 v208, s[72:75], s59 offen lds
    s_add_u32 m0, s56, 7168
    s_mov_b32 s59, 385024
    buffer_load_dwordx4 v208, s[72:75], s59 offen lds
    v_mfma_f32_32x32x16_bf16 v[64:79], v[152:155], v[40:43], v[64:79]
    v_mfma_f32_32x32x16_bf16 v[80:95], v[152:155], v[44:47], v[80:95]
    v_mfma_f32_32x32x16_bf16 v[96:111], v[156:159], v[40:43], v[96:111]
    v_mfma_f32_32x32x16_bf16 v[112:127], v[156:159], v[44:47], v[112:127]
    s_waitcnt vmcnt(28) lgkmcnt(0)
    v_mfma_f32_32x32x16_bf16 v[64:79], v[160:163], v[192:195], v[64:79]
    ds_read_b64_tr_b16 v[144:145], v8 offset:12288
    ds_read_b64_tr_b16 v[146:147], v8 offset:12800
    s_add_u32 m0, s56, 8192
    s_mov_b32 s59, 393216
    buffer_load_dwordx4 v208, s[72:75], s59 offen lds
    s_add_u32 m0, s56, 9216
    s_mov_b32 s59, 401408
    buffer_load_dwordx4 v208, s[72:75], s59 offen lds
    v_mfma_f32_32x32x16_bf16 v[80:95], v[160:163], v[196:199], v[80:95]
    ds_read_b64_tr_b16 v[148:149], v9 offset:12288
    ds_read_b64_tr_b16 v[150:151], v9 offset:12800
    s_add_u32 m0, s56, 10240
    s_mov_b32 s59, 409600
    buffer_load_dwordx4 v208, s[72:75], s59 offen lds
    s_add_u32 m0, s56, 11264
    s_mov_b32 s59, 417792
    buffer_load_dwordx4 v208, s[72:75], s59 offen lds
    v_mfma_f32_32x32x16_bf16 v[96:111], v[164:167], v[192:195], v[96:111]
    ds_read_b64_tr_b16 v[152:153], v8 offset:14336
    ds_read_b64_tr_b16 v[154:155], v8 offset:14848
    v_mfma_f32_32x32x16_bf16 v[112:127], v[164:167], v[196:199], v[112:127]
    ds_read_b64_tr_b16 v[156:157], v9 offset:14336
    ds_read_b64_tr_b16 v[158:159], v9 offset:14848
    v_mfma_f32_32x32x16_bf16 v[64:79], v[168:171], v[200:203], v[64:79]
    v_mfma_f32_32x32x16_bf16 v[80:95], v[168:171], v[204:207], v[80:95]
    v_mfma_f32_32x32x16_bf16 v[96:111], v[172:175], v[200:203], v[96:111]
    v_mfma_f32_32x32x16_bf16 v[112:127], v[172:175], v[204:207], v[112:127]
    s_waitcnt vmcnt(28) lgkmcnt(0)
    v_mfma_f32_32x32x16_bf16 v[64:79], v[144:147], v[48:51], v[64:79]
    ds_read_b64_tr_b16 v[32:33], v8 offset:16384
    ds_read_b64_tr_b16 v[34:35], v8 offset:16896
    s_add_u32 m0, s56, 12288
    s_mov_b32 s59, 425984
    buffer_load_dwordx4 v208, s[72:75], s59 offen lds
    s_add_u32 m0, s56, 13312
    s_mov_b32 s59, 434176
    buffer_load_dwordx4 v208, s[72:75], s59 offen lds
    v_mfma_f32_32x32x16_bf16 v[80:95], v[144:147], v[52:55], v[80:95]
    ds_read_b64_tr_b16 v[36:37], v9 offset:16384
    ds_read_b64_tr_b16 v[38:39], v9 offset:16896
    s_add_u32 m0, s56, 14336
    s_mov_b32 s59, 442368
    buffer_load_dwordx4 v208, s[72:75], s59 offen lds
    s_add_u32 m0, s56, 15360
    s_mov_b32 s59, 450560
    buffer_load_dwordx4 v208, s[72:75], s59 offen lds
    v_mfma_f32_32x32x16_bf16 v[96:111], v[148:151], v[48:51], v[96:111]
    ds_read_b64_tr_b16 v[40:41], v8 offset:18432
    ds_read_b64_tr_b16 v[42:43], v8 offset:18944
    v_mfma_f32_32x32x16_bf16 v[112:127], v[148:151], v[52:55], v[112:127]
    ds_read_b64_tr_b16 v[44:45], v9 offset:18432
    ds_read_b64_tr_b16 v[46:47], v9 offset:18944
    v_mfma_f32_32x32x16_bf16 v[64:79], v[152:155], v[56:59], v[64:79]
    v_mfma_f32_32x32x16_bf16 v[80:95], v[152:155], v[60:63], v[80:95]
    v_mfma_f32_32x32x16_bf16 v[96:111], v[156:159], v[56:59], v[96:111]
    v_mfma_f32_32x32x16_bf16 v[112:127], v[156:159], v[60:63], v[112:127]
    s_waitcnt vmcnt(28) lgkmcnt(0)
    v_mfma_f32_32x32x16_bf16 v[64:79], v[32:35], v[224:227], v[64:79]
    ds_read_b64_tr_b16 v[160:161], v8 offset:0
    ds_read_b64_tr_b16 v[162:163], v8 offset:512
    v_mfma_f32_32x32x16_bf16 v[80:95], v[32:35], v[228:231], v[80:95]
    ds_read_b64_tr_b16 v[164:165], v9 offset:0
    ds_read_b64_tr_b16 v[166:167], v9 offset:512
    v_mfma_f32_32x32x16_bf16 v[96:111], v[36:39], v[224:227], v[96:111]
    ds_read_b64_tr_b16 v[168:169], v8 offset:2048
    ds_read_b64_tr_b16 v[170:171], v8 offset:2560
    v_mfma_f32_32x32x16_bf16 v[112:127], v[36:39], v[228:231], v[112:127]
    ds_read_b64_tr_b16 v[172:173], v9 offset:2048
    ds_read_b64_tr_b16 v[174:175], v9 offset:2560
    v_mfma_f32_32x32x16_bf16 v[64:79], v[40:43], v[232:235], v[64:79]
    v_mfma_f32_32x32x16_bf16 v[80:95], v[40:43], v[236:239], v[80:95]
    v_mfma_f32_32x32x16_bf16 v[96:111], v[44:47], v[232:235], v[96:111]
    v_mfma_f32_32x32x16_bf16 v[112:127], v[44:47], v[236:239], v[112:127]
    s_waitcnt vmcnt(8) lgkmcnt(0)
    buffer_load_dwordx2 v[222:223], v6, s[52:55], 0 offen sc1
    v_mfma_f32_32x32x16_bf16 v[64:79], v[160:163], v[128:131], v[64:79]
    ds_read_b64_tr_b16 v[192:193], v8 offset:4096
    ds_read_b64_tr_b16 v[194:195], v8 offset:4608
    v_mfma_f32_32x32x16_bf16 v[80:95], v[160:163], v[132:135], v[80:95]
    ds_read_b64_tr_b16 v[196:197], v9 offset:4096
    ds_read_b64_tr_b16 v[198:199], v9 offset:4608
    v_mfma_f32_32x32x16_bf16 v[96:111], v[164:167], v[128:131], v[96:111]
    ds_read_b64_tr_b16 v[200:201], v8 offset:6144
    ds_read_b64_tr_b16 v[202:203], v8 offset:6656
    v_mfma_f32_32x32x16_bf16 v[112:127], v[164:167], v[132:135], v[112:127]
    ds_read_b64_tr_b16 v[204:205], v9 offset:6144
    ds_read_b64_tr_b16 v[206:207], v9 offset:6656
    v_mfma_f32_32x32x16_bf16 v[64:79], v[168:171], v[136:139], v[64:79]
    v_mfma_f32_32x32x16_bf16 v[80:95], v[168:171], v[140:143], v[80:95]
    v_mfma_f32_32x32x16_bf16 v[96:111], v[172:175], v[136:139], v[96:111]
    v_mfma_f32_32x32x16_bf16 v[112:127], v[172:175], v[140:143], v[112:127]
    s_waitcnt vmcnt(5) lgkmcnt(0)
    v_mfma_f32_32x32x16_bf16 v[64:79], v[192:195], v[240:243], v[64:79]
    ds_read_b64_tr_b16 v[144:145], v8 offset:8192
    ds_read_b64_tr_b16 v[146:147], v8 offset:8704
    v_mfma_f32_32x32x16_bf16 v[80:95], v[192:195], v[244:247], v[80:95]
    ds_read_b64_tr_b16 v[148:149], v9 offset:8192
    ds_read_b64_tr_b16 v[150:151], v9 offset:8704
    v_mfma_f32_32x32x16_bf16 v[96:111], v[196:199], v[240:243], v[96:111]
    ds_read_b64_tr_b16 v[152:153], v8 offset:10240
    ds_read_b64_tr_b16 v[154:155], v8 offset:10752
    v_mfma_f32_32x32x16_bf16 v[112:127], v[196:199], v[244:247], v[112:127]
    ds_read_b64_tr_b16 v[156:157], v9 offset:10240
    ds_read_b64_tr_b16 v[158:159], v9 offset:10752
    v_mfma_f32_32x32x16_bf16 v[64:79], v[200:203], v[248:251], v[64:79]
    v_mfma_f32_32x32x16_bf16 v[80:95], v[200:203], v[252:255], v[80:95]
    v_mfma_f32_32x32x16_bf16 v[96:111], v[204:207], v[248:251], v[96:111]
    v_mfma_f32_32x32x16_bf16 v[112:127], v[204:207], v[252:255], v[112:127]
    s_waitcnt vmcnt(1) lgkmcnt(0)
    v_mfma_f32_32x32x16_bf16 v[64:79], v[144:147], v[16:19], v[64:79]
    ds_read_b64_tr_b16 v[48:49], v8 offset:12288
    ds_read_b64_tr_b16 v[50:51], v8 offset:12800
    v_mfma_f32_32x32x16_bf16 v[80:95], v[144:147], v[20:23], v[80:95]
    ds_read_b64_tr_b16 v[52:53], v9 offset:12288
    ds_read_b64_tr_b16 v[54:55], v9 offset:12800
    v_mfma_f32_32x32x16_bf16 v[96:111], v[148:151], v[16:19], v[96:111]
    ds_read_b64_tr_b16 v[56:57], v8 offset:14336
    ds_read_b64_tr_b16 v[58:59], v8 offset:14848
    v_mfma_f32_32x32x16_bf16 v[112:127], v[148:151], v[20:23], v[112:127]
    ds_read_b64_tr_b16 v[60:61], v9 offset:14336
    ds_read_b64_tr_b16 v[62:63], v9 offset:14848
    v_mfma_f32_32x32x16_bf16 v[64:79], v[152:155], v[24:27], v[64:79]
    v_mfma_f32_32x32x16_bf16 v[80:95], v[152:155], v[28:31], v[80:95]
    v_mfma_f32_32x32x16_bf16 v[96:111], v[156:159], v[24:27], v[96:111]
    v_mfma_f32_32x32x16_bf16 v[112:127], v[156:159], v[28:31], v[112:127]
    s_waitcnt vmcnt(13) lgkmcnt(0)
    v_mfma_f32_32x32x16_bf16 v[64:79], v[48:51], v[176:179], v[64:79]
    v_mfma_f32_32x32x16_bf16 v[80:95], v[48:51], v[180:183], v[80:95]
    v_mfma_f32_32x32x16_bf16 v[96:111], v[52:55], v[176:179], v[96:111]
    v_mfma_f32_32x32x16_bf16 v[112:127], v[52:55], v[180:183], v[112:127]
    v_mfma_f32_32x32x16_bf16 v[64:79], v[56:59], v[184:187], v[64:79]
    v_mfma_f32_32x32x16_bf16 v[80:95], v[56:59], v[188:191], v[80:95]
    v_mfma_f32_32x32x16_bf16 v[96:111], v[60:63], v[184:187], v[96:111]
    v_mfma_f32_32x32x16_bf16 v[112:127], v[60:63], v[188:191], v[112:127]
    s_waitcnt vmcnt(0)
    s_branch G2_CHK
G2_POLL:
    s_sleep 8
    buffer_load_dwordx2 v[222:223], v6, s[52:55], 0 offen sc1
    s_waitcnt vmcnt(0)
G2_CHK:
    v_cmp_ne_u32 vcc, v222, v220
    v_cmp_ne_u32 s[60:61], v223, v221
    s_nop 1
    s_or_b64 vcc, vcc, s[60:61]
    s_cmp_eq_u64 vcc, 0
    s_cbranch_scc0 G2_POLL
G2_GO:
    s_mov_b32 s60, 0
    buffer_load_ushort v32, v7, s[80:83], s60 offen sc1
    s_mov_b32 s60, 4096
    buffer_load_ushort v33, v7, s[80:83], s60 offen sc1
    s_mov_b32 s60, 8192
    buffer_load_ushort v34, v7, s[80:83], s60 offen sc1
    s_mov_b32 s60, 12288
    buffer_load_ushort v35, v7, s[80:83], s60 offen sc1
    s_mov_b32 s60, 16384
    buffer_load_ushort v36, v7, s[80:83], s60 offen sc1
    s_mov_b32 s60, 20480
    buffer_load_ushort v37, v7, s[80:83], s60 offen sc1
    s_mov_b32 s60, 24576
    buffer_load_ushort v38, v7, s[80:83], s60 offen sc1
    s_mov_b32 s60, 28672
    buffer_load_ushort v39, v7, s[80:83], s60 offen sc1
    s_mov_b32 s60, 131072
    buffer_load_ushort v40, v7, s[80:83], s60 offen sc1
    s_mov_b32 s60, 135168
    buffer_load_ushort v41, v7, s[80:83], s60 offen sc1
    s_mov_b32 s60, 139264
    buffer_load_ushort v42, v7, s[80:83], s60 offen sc1
    s_mov_b32 s60, 143360
    buffer_load_ushort v43, v7, s[80:83], s60 offen sc1
    s_mov_b32 s60, 147456
    buffer_load_ushort v44, v7, s[80:83], s60 offen sc1
    s_mov_b32 s60, 151552
    buffer_load_ushort v45, v7, s[80:83], s60 offen sc1
    s_mov_b32 s60, 155648
    buffer_load_ushort v46, v7, s[80:83], s60 offen sc1
    s_mov_b32 s60, 159744
    buffer_load_ushort v47, v7, s[80:83], s60 offen sc1
    buffer_load_dword v210, v14, s[84:87], 0 offen sc1
G2_ZOK:
    v_and_b32 v4, 31, v0
    s_movk_i32 s60, 272
    v_mul_lo_u32 v4, v4, s60
    v_lshrrev_b32 v5, 5, v0
    v_lshl_add_u32 v4, v5, 4, v4
    v_add_u32 v4, s56, v4
    ds_write_b128 v4, v[64:67] offset:0
    ds_write_b128 v4, v[68:71] offset:32
    ds_write_b128 v4, v[72:75] offset:64
    ds_write_b128 v4, v[76:79] offset:96
    ds_write_b128 v4, v[80:83] offset:8704
    ds_write_b128 v4, v[84:87] offset:8736
    ds_write_b128 v4, v[88:91] offset:8768
    ds_write_b128 v4, v[92:95] offset:8800
    ds_write_b128 v4, v[96:99] offset:128
    ds_write_b128 v4, v[100:103] offset:160
    ds_write_b128 v4, v[104:107] offset:192
    ds_write_b128 v4, v[108:111] offset:224
    ds_write_b128 v4, v[112:115] offset:8832
    ds_write_b128 v4, v[116:119] offset:8864
    ds_write_b128 v4, v[120:123] offset:8896
    ds_write_b128 v4, v[124:127] offset:8928
    s_waitcnt lgkmcnt(0)
    s_barrier
    s_lshl_b32 s60, s20, 4
    v_add_u32 v5, s60, v10
    s_movk_i32 s60, 272
    v_mul_lo_u32 v5, v5, s60
    v_lshl_add_u32 v5, v11, 5, v5
    ds_read_b128 v[64:67], v5 offset:0
    ds_read_b128 v[68:71], v5 offset:16
    ds_read_b128 v[72:75], v5 offset:128
    ds_read_b128 v[76:79], v5 offset:144
    ds_read_b128 v[80:83], v5 offset:20480
    ds_read_b128 v[84:87], v5 offset:20496
    ds_read_b128 v[88:91], v5 offset:20608
    ds_read_b128 v[92:95], v5 offset:20624
    ds_read_b128 v[96:99], v5 offset:40960
    ds_read_b128 v[100:103], v5 offset:40976
    ds_read_b128 v[104:107], v5 offset:41088
    ds_read_b128 v[108:111], v5 offset:41104
    ds_read_b128 v[112:115], v5 offset:61440
    ds_read_b128 v[116:119], v5 offset:61456
    ds_read_b128 v[120:123], v5 offset:61568
    ds_read_b128 v[124:127], v5 offset:61584
    s_waitcnt lgkmcnt(0)
    v_add_f32 v64, v64, v80
    v_add_f32 v96, v96, v112
    v_add_f32 v65, v65, v81
    v_add_f32 v97, v97, v113
    v_add_f32 v66, v66, v82
    v_add_f32 v98, v98, v114
    v_add_f32 v67, v67, v83
    v_add_f32 v99, v99, v115
    v_add_f32 v68, v68, v84
    v_add_f32 v100, v100, v116
    v_add_f32 v69, v69, v85
    v_add_f32 v101, v101, v117
    v_add_f32 v70, v70, v86
    v_add_f32 v102, v102, v118
    v_add_f32 v71, v71, v87
    v_add_f32 v103, v103, v119
    v_add_f32 v72, v72, v88
    v_add_f32 v104, v104, v120
    v_add_f32 v73, v73, v89
    v_add_f32 v105, v105, v121
    v_add_f32 v74, v74, v90
    v_add_f32 v106, v106, v122
    v_add_f32 v75, v75, v91
    v_add_f32 v107, v107, v123
    v_add_f32 v76, v76, v92
    v_add_f32 v108, v108, v124
    v_add_f32 v77, v77, v93
    v_add_f32 v109, v109, v125
    v_add_f32 v78, v78, v94
    v_add_f32 v110, v110, v126
    v_add_f32 v79, v79, v95
    v_add_f32 v111, v111, v127
    v_add_f32 v64, v64, v96
    v_add_f32 v65, v65, v97
    v_add_f32 v66, v66, v98
    v_add_f32 v67, v67, v99
    v_add_f32 v68, v68, v100
    v_add_f32 v69, v69, v101
    v_add_f32 v70, v70, v102
    v_add_f32 v71, v71, v103
    v_add_f32 v72, v72, v104
    v_add_f32 v73, v73, v105
    v_add_f32 v74, v74, v106
    v_add_f32 v75, v75, v107
    v_add_f32 v76, v76, v108
    v_add_f32 v77, v77, v109
    v_add_f32 v78, v78, v110
    v_add_f32 v79, v79, v111
    s_mov_b32 s62, 0xffff0000
    v_cvt_pk_bf16_f32 v25, v64, v65
    v_lshlrev_b32 v64, 16, v25
    v_and_b32 v65, s62, v25
    v_cvt_pk_bf16_f32 v25, v66, v67
    v_lshlrev_b32 v66, 16, v25
    v_and_b32 v67, s62, v25
    v_cvt_pk_bf16_f32 v25, v68, v69
    v_lshlrev_b32 v68, 16, v25
    v_and_b32 v69, s62, v25
    v_cvt_pk_bf16_f32 v25, v70, v71
    v_lshlrev_b32 v70, 16, v25
    v_and_b32 v71, s62, v25
    v_cvt_pk_bf16_f32 v25, v72, v73
    v_lshlrev_b32 v72, 16, v25
    v_and_b32 v73, s62, v25
    v_cvt_pk_bf16_f32 v25, v74, v75
    v_lshlrev_b32 v74, 16, v25
    v_and_b32 v75, s62, v25
    v_cvt_pk_bf16_f32 v25, v76, v77
    v_lshlrev_b32 v76, 16, v25
    v_and_b32 v77, s62, v25
    v_cvt_pk_bf16_f32 v25, v78, v79
    v_lshlrev_b32 v78, 16, v25
    v_and_b32 v79, s62, v25
    s_waitcnt vmcnt(0)
    v_sub_f32 v26, 1.0, v210
    v_mov_b32 v27, v26
    v_cvt_pk_bf16_f32 v25, v26, v27
    v_lshlrev_b32 v26, 16, v25
    v_and_b32 v27, s62, v25
    v_mul_f32 v64, v64, v26
    v_mul_f32 v65, v65, v26
    v_mul_f32 v66, v66, v26
    v_mul_f32 v67, v67, v26
    v_mul_f32 v68, v68, v26
    v_mul_f32 v69, v69, v26
    v_mul_f32 v70, v70, v26
    v_mul_f32 v71, v71, v26
    v_mul_f32 v72, v72, v26
    v_mul_f32 v73, v73, v26
    v_mul_f32 v74, v74, v26
    v_mul_f32 v75, v75, v26
    v_mul_f32 v76, v76, v26
    v_mul_f32 v77, v77, v26
    v_mul_f32 v78, v78, v26
    v_mul_f32 v79, v79, v26
    v_cvt_pk_bf16_f32 v25, v64, v65
    v_lshlrev_b32 v64, 16, v25
    v_and_b32 v65, s62, v25
    v_cvt_pk_bf16_f32 v25, v66, v67
    v_lshlrev_b32 v66, 16, v25
    v_and_b32 v67, s62, v25
    v_cvt_pk_bf16_f32 v25, v68, v69
    v_lshlrev_b32 v68, 16, v25
    v_and_b32 v69, s62, v25
    v_cvt_pk_bf16_f32 v25, v70, v71
    v_lshlrev_b32 v70, 16, v25
    v_and_b32 v71, s62, v25
    v_cvt_pk_bf16_f32 v25, v72, v73
    v_lshlrev_b32 v72, 16, v25
    v_and_b32 v73, s62, v25
    v_cvt_pk_bf16_f32 v25, v74, v75
    v_lshlrev_b32 v74, 16, v25
    v_and_b32 v75, s62, v25
    v_cvt_pk_bf16_f32 v25, v76, v77
    v_lshlrev_b32 v76, 16, v25
    v_and_b32 v77, s62, v25
    v_cvt_pk_bf16_f32 v25, v78, v79
    v_lshlrev_b32 v78, 16, v25
    v_and_b32 v79, s62, v25
    v_lshlrev_b32 v96, 16, v212
    v_and_b32 v97, s62, v212
    v_lshlrev_b32 v98, 16, v32
    v_lshlrev_b32 v99, 16, v33
    v_mul_f32 v96, v96, v98
    v_mul_f32 v97, v97, v99
    v_cvt_pk_bf16_f32 v25, v96, v97
    v_lshlrev_b32 v96, 16, v25
    v_and_b32 v97, s62, v25
    v_mul_f32 v96, v96, v210
    v_mul_f32 v97, v97, v210
    v_cvt_pk_bf16_f32 v25, v96, v97
    v_lshlrev_b32 v96, 16, v25
    v_and_b32 v97, s62, v25
    v_add_f32 v96, v96, v64
    v_add_f32 v97, v97, v65
    v_cvt_pk_bf16_f32 v100, v96, v97
    v_lshlrev_b32 v96, 16, v213
    v_and_b32 v97, s62, v213
    v_lshlrev_b32 v98, 16, v34
    v_lshlrev_b32 v99, 16, v35
    v_mul_f32 v96, v96, v98
    v_mul_f32 v97, v97, v99
    v_cvt_pk_bf16_f32 v25, v96, v97
    v_lshlrev_b32 v96, 16, v25
    v_and_b32 v97, s62, v25
    v_mul_f32 v96, v96, v210
    v_mul_f32 v97, v97, v210
    v_cvt_pk_bf16_f32 v25, v96, v97
    v_lshlrev_b32 v96, 16, v25
    v_and_b32 v97, s62, v25
    v_add_f32 v96, v96, v66
    v_add_f32 v97, v97, v67
    v_cvt_pk_bf16_f32 v101, v96, v97
    v_lshlrev_b32 v96, 16, v214
    v_and_b32 v97, s62, v214
    v_lshlrev_b32 v98, 16, v36
    v_lshlrev_b32 v99, 16, v37
    v_mul_f32 v96, v96, v98
    v_mul_f32 v97, v97, v99
    v_cvt_pk_bf16_f32 v25, v96, v97
    v_lshlrev_b32 v96, 16, v25
    v_and_b32 v97, s62, v25
    v_mul_f32 v96, v96, v210
    v_mul_f32 v97, v97, v210
    v_cvt_pk_bf16_f32 v25, v96, v97
    v_lshlrev_b32 v96, 16, v25
    v_and_b32 v97, s62, v25
    v_add_f32 v96, v96, v68
    v_add_f32 v97, v97, v69
    v_cvt_pk_bf16_f32 v102, v96, v97
    v_lshlrev_b32 v96, 16, v215
    v_and_b32 v97, s62, v215
    v_lshlrev_b32 v98, 16, v38
    v_lshlrev_b32 v99, 16, v39
    v_mul_f32 v96, v96, v98
    v_mul_f32 v97, v97, v99
    v_cvt_pk_bf16_f32 v25, v96, v97
    v_lshlrev_b32 v96, 16, v25
    v_and_b32 v97, s62, v25
    v_mul_f32 v96, v96, v210
    v_mul_f32 v97, v97, v210
    v_cvt_pk_bf16_f32 v25, v96, v97
    v_lshlrev_b32 v96, 16, v25
    v_and_b32 v97, s62, v25
    v_add_f32 v96, v96, v70
    v_add_f32 v97, v97, v71
    v_cvt_pk_bf16_f32 v103, v96, v97
    buffer_store_dwordx4 v[100:103], v13, s[96:99], 0 offen offset:0 sc1 nt
    v_lshlrev_b32 v96, 16, v216
    v_and_b32 v97, s62, v216
    v_lshlrev_b32 v98, 16, v40
    v_lshlrev_b32 v99, 16, v41
    v_mul_f32 v96, v96, v98
    v_mul_f32 v97, v97, v99
    v_cvt_pk_bf16_f32 v25, v96, v97
    v_lshlrev_b32 v96, 16, v25
    v_and_b32 v97, s62, v25
    v_mul_f32 v96, v96, v210
    v_mul_f32 v97, v97, v210
    v_cvt_pk_bf16_f32 v25, v96, v97
    v_lshlrev_b32 v96, 16, v25
    v_and_b32 v97, s62, v25
    v_add_f32 v96, v96, v72
    v_add_f32 v97, v97, v73
    v_cvt_pk_bf16_f32 v104, v96, v97
    v_lshlrev_b32 v96, 16, v217
    v_and_b32 v97, s62, v217
    v_lshlrev_b32 v98, 16, v42
    v_lshlrev_b32 v99, 16, v43
    v_mul_f32 v96, v96, v98
    v_mul_f32 v97, v97, v99
    v_cvt_pk_bf16_f32 v25, v96, v97
    v_lshlrev_b32 v96, 16, v25
    v_and_b32 v97, s62, v25
    v_mul_f32 v96, v96, v210
    v_mul_f32 v97, v97, v210
    v_cvt_pk_bf16_f32 v25, v96, v97
    v_lshlrev_b32 v96, 16, v25
    v_and_b32 v97, s62, v25
    v_add_f32 v96, v96, v74
    v_add_f32 v97, v97, v75
    v_cvt_pk_bf16_f32 v105, v96, v97
    v_lshlrev_b32 v96, 16, v218
    v_and_b32 v97, s62, v218
    v_lshlrev_b32 v98, 16, v44
    v_lshlrev_b32 v99, 16, v45
    v_mul_f32 v96, v96, v98
    v_mul_f32 v97, v97, v99
    v_cvt_pk_bf16_f32 v25, v96, v97
    v_lshlrev_b32 v96, 16, v25
    v_and_b32 v97, s62, v25
    v_mul_f32 v96, v96, v210
    v_mul_f32 v97, v97, v210
    v_cvt_pk_bf16_f32 v25, v96, v97
    v_lshlrev_b32 v96, 16, v25
    v_and_b32 v97, s62, v25
    v_add_f32 v96, v96, v76
    v_add_f32 v97, v97, v77
    v_cvt_pk_bf16_f32 v106, v96, v97
    v_lshlrev_b32 v96, 16, v219
    v_and_b32 v97, s62, v219
    v_lshlrev_b32 v98, 16, v46
    v_lshlrev_b32 v99, 16, v47
    v_mul_f32 v96, v96, v98
    v_mul_f32 v97, v97, v99
    v_cvt_pk_bf16_f32 v25, v96, v97
    v_lshlrev_b32 v96, 16, v25
    v_and_b32 v97, s62, v25
    v_mul_f32 v96, v96, v210
    v_mul_f32 v97, v97, v210
    v_cvt_pk_bf16_f32 v25, v96, v97
    v_lshlrev_b32 v96, 16, v25
    v_and_b32 v97, s62, v25
    v_add_f32 v96, v96, v78
    v_add_f32 v97, v97, v79
    v_cvt_pk_bf16_f32 v107, v96, v97
    buffer_store_dwordx4 v[104:107], v13, s[96:99], 0 offen offset:64 sc1 nt
    s_endpgm
F_B:
    s_sub_u32 s2, s2, 256
    s_load_dwordx4 s[4:7], s[0:1], 0
    s_load_dwordx4 s[8:11], s[0:1], 16
    s_load_dwordx4 s[12:15], s[0:1], 32
    s_load_dwordx2 s[16:17], s[0:1], 72
    s_load_dwordx2 s[22:23], s[0:1], 88
    s_load_dwordx2 s[18:19], s[0:1], 96
    s_load_dwordx4 s[56:59], s[0:1], 56
    s_setprio 3
    s_lshr_b32 s24, s20, 1
    s_and_b32 s25, s20, 1
    s_and_b32 s26, s2, 7
    s_lshl_b32 s26, s26, 6
    s_lshr_b32 s27, s2, 3
    s_lshl_b32 s27, s27, 1
    s_add_u32 s26, s26, s27
    s_add_u32 s26, s26, s24
    s_lshl_b32 s27, s26, 12
    s_mul_i32 s28, s24, 29440
    v_lshlrev_b32 v1, 4, v0
    s_waitcnt lgkmcnt(0)
    s_lshr_b32 s60, s2, 3
    s_and_b32 s61, s2, 7
    s_mov_b32 s64, s6
    s_mov_b32 s65, s7
    s_mov_b32 s66, 0x200000
    s_mov_b32 s67, 0x00020000
    s_mov_b32 s68, s8
    s_mov_b32 s69, s9
    s_mov_b32 s70, 0x200000
    s_mov_b32 s71, 0x00020000
    s_mov_b32 s72, s10
    s_mov_b32 s73, s11
    s_mov_b32 s74, 0x1000
    s_mov_b32 s75, 0x00020000
    s_add_u32 s76, s18, 0x800000
    s_addc_u32 s77, s19, 0
    s_mov_b32 s78, 0x200000
    s_mov_b32 s79, 0x00020000
    s_mov_b32 s80, s4
    s_mov_b32 s81, s5
    s_mov_b32 s82, 0x200000
    s_mov_b32 s83, 0x00020000
    s_mov_b32 s84, s16
    s_mov_b32 s85, s17
    s_mov_b32 s86, 0x400
    s_mov_b32 s87, 0x00020000
    s_add_u32 s88, s18, 0xa00000
    s_addc_u32 s89, s19, 0
    s_mov_b32 s90, 0x2000
    s_mov_b32 s91, 0x00020000
    v_and_b32 v129, 31, v0
    v_lshrrev_b32 v130, 5, v0
    s_lshl_b32 s62, s20, 1
    v_add_u32 v130, s62, v130
    s_lshl_b32 s62, s60, 6
    v_lshl_add_u32 v131, v130, 3, s62
    v_lshlrev_b32 v132, 10, v131
    s_lshl_b32 s63, s61, 7
    v_lshl_add_u32 v133, v129, 2, s63
    v_add_u32 v132, v132, v133
    v_add_u32 v134, 0xfffff400, v132
    buffer_load_dword v144, v134, s[64:67], 0 offen
    v_add_u32 v134, 0xfffff800, v132
    buffer_load_dword v145, v134, s[64:67], 0 offen
    v_add_u32 v134, 0xfffffc00, v132
    buffer_load_dword v146, v134, s[64:67], 0 offen
    v_add_u32 v134, 0x0, v132
    buffer_load_dword v147, v134, s[64:67], 0 offen
    v_add_u32 v134, 0x400, v132
    buffer_load_dword v148, v134, s[64:67], 0 offen
    v_add_u32 v134, 0x800, v132
    buffer_load_dword v149, v134, s[64:67], 0 offen
    v_add_u32 v134, 0xc00, v132
    buffer_load_dword v150, v134, s[64:67], 0 offen
    v_add_u32 v134, 0x1000, v132
    buffer_load_dword v151, v134, s[64:67], 0 offen
    v_add_u32 v134, 0x1400, v132
    buffer_load_dword v152, v134, s[64:67], 0 offen
    v_add_u32 v134, 0x1800, v132
    buffer_load_dword v153, v134, s[64:67], 0 offen
    v_add_u32 v134, 0x1c00, v132
    buffer_load_dword v154, v134, s[64:67], 0 offen
    buffer_load_dword v160, v132, s[68:71], 0 offen offset:0
    buffer_load_dword v161, v132, s[68:71], 0 offen offset:1024
    buffer_load_dword v162, v132, s[68:71], 0 offen offset:2048
    buffer_load_dword v163, v132, s[68:71], 0 offen offset:3072
    v_add_u32 v134, 4096, v132
    buffer_load_dword v164, v134, s[68:71], 0 offen offset:0
    buffer_load_dword v165, v134, s[68:71], 0 offen offset:1024
    buffer_load_dword v166, v134, s[68:71], 0 offen offset:2048
    buffer_load_dword v167, v134, s[68:71], 0 offen offset:3072
    v_lshlrev_b32 v134, 2, v133
    buffer_load_dwordx4 v[168:171], v134, s[72:75], 0 offen
    s_lshl_b32 s92, s2, 3
    s_lshl_b32 s93, s20, 1
    s_add_u32 s92, s92, s93
    s_lshl_b32 s93, s92, 10
    v_lshlrev_b32 v135, 4, v0
    buffer_load_dwordx4 v[172:175], v135, s[80:83], s93 offen
    buffer_load_dwordx4 v[176:179], v135, s[80:83], s93 offen offset:1024
    buffer_load_dwordx4 v[180:183], v135, s[84:87], 0 offen
    s_mov_b32 s94, 0xffff0000
    s_mov_b32 s95, 0x05040100
    s_mov_b32 s96, 0x07060302
    v_lshlrev_b32 v136, 1, v129
    s_lshl_b32 s93, s61, 6
    v_add_u32 v136, s93, v136
    v_lshlrev_b32 v136, 12, v136
    v_sub_u32 v137, 2040, v131
    v_lshl_add_u32 v136, v137, 1, v136
    v_add_u32 v137, 4096, v136
    s_lshr_b32 s29, s2, 3
    s_lshl_b32 s29, s29, 2
    s_add_u32 s29, s29, s20
    s_lshl_b32 s21, s29, 13
    s_add_u32 s32, s12, s27
    s_addc_u32 s33, s13, 0
    s_mov_b32 s34, 4096
    s_mov_b32 s35, 0x00020000
    s_add_u32 s36, s18, 0x800000
    s_addc_u32 s37, s19, 0
    s_mov_b32 s38, 0x200000
    s_mov_b32 s39, 0x00020000
    s_add_u32 s40, s18, 0xb00000
    s_addc_u32 s41, s19, 0
    s_mov_b32 s42, 0x200000
    s_mov_b32 s43, 0x00020000
    s_mov_b32 s44, s14
    s_mov_b32 s45, s15
    s_mov_b32 s46, 0x400
    s_mov_b32 s47, 0x00020000
    s_mov_b32 s48, s22
    s_mov_b32 s49, s23
    s_mov_b32 s50, 0x100
    s_mov_b32 s51, 0x00020000
    s_add_u32 s60, s18, 0xf00000
    s_addc_u32 s61, s19, 0
    s_mov_b32 s62, 0x18000
    s_mov_b32 s63, 0x00020000
    s_lshl_b32 s29, s26, 1
    v_mov_b32 v2, s29
    buffer_load_ushort v3, v2, s[44:47], 0 offen
    s_lshl_b32 s29, s25, 10
    v_add_u32 v4, s29, v1
    v_add_u32 v5, 0xffffffe0, v4
    v_add_u32 v6, 0xfffffff0, v4
    buffer_load_dwordx4 v[16:19], v5, s[32:35], 0 offen
    buffer_load_dwordx4 v[20:23], v6, s[32:35], 0 offen
    v_add_u32 v5, 0x7e0, v4
    v_add_u32 v6, 0x7f0, v4
    buffer_load_dwordx4 v[24:27], v5, s[32:35], 0 offen
    buffer_load_dwordx4 v[28:31], v6, s[32:35], 0 offen
    v_add_u32 v5, 0xfe0, v4
    v_add_u32 v6, 0xff0, v4
    buffer_load_dwordx4 v[32:35], v5, s[32:35], 0 offen
    buffer_load_dwordx4 v[36:39], v6, s[32:35], 0 offen
    s_setprio 0
    s_waitcnt vmcnt(7)
    v_lshlrev_b32 v184, 16, v168
    v_lshlrev_b32 v185, 16, v170
    v_and_b32 v186, s94, v168
    v_and_b32 v187, s94, v170
    v_lshlrev_b32 v188, 16, v169
    v_lshlrev_b32 v189, 16, v171
    v_and_b32 v190, s94, v169
    v_and_b32 v191, s94, v171
    v_lshlrev_b32 v192, 16, v144
    v_and_b32 v193, s94, v144
    v_lshlrev_b32 v194, 16, v145
    v_and_b32 v195, s94, v145
    v_lshlrev_b32 v196, 16, v146
    v_and_b32 v197, s94, v146
    v_lshlrev_b32 v198, 16, v147
    v_and_b32 v199, s94, v147
    v_lshlrev_b32 v200, 16, v148
    v_and_b32 v201, s94, v148
    v_lshlrev_b32 v202, 16, v149
    v_and_b32 v203, s94, v149
    v_lshlrev_b32 v204, 16, v150
    v_and_b32 v205, s94, v150
    v_lshlrev_b32 v206, 16, v151
    v_and_b32 v207, s94, v151
    v_lshlrev_b32 v208, 16, v152
    v_and_b32 v209, s94, v152
    v_lshlrev_b32 v210, 16, v153
    v_and_b32 v211, s94, v153
    v_lshlrev_b32 v212, 16, v154
    v_and_b32 v213, s94, v154
    v_pk_mul_f32 v[216:217], v[192:193], v[190:191]
    v_cvt_pk_bf16_f32 v220, v216, v217
    v_lshlrev_b32 v216, 16, v220
    v_and_b32 v217, s94, v220
    v_pk_mul_f32 v[218:219], v[194:195], v[188:189]
    v_cvt_pk_bf16_f32 v220, v218, v219
    v_lshlrev_b32 v218, 16, v220
    v_and_b32 v219, s94, v220
    v_pk_add_f32 v[216:217], v[216:217], v[218:219]
    v_cvt_pk_bf16_f32 v220, v216, v217
    v_lshlrev_b32 v216, 16, v220
    v_and_b32 v217, s94, v220
    v_pk_mul_f32 v[218:219], v[196:197], v[186:187]
    v_cvt_pk_bf16_f32 v220, v218, v219
    v_lshlrev_b32 v218, 16, v220
    v_and_b32 v219, s94, v220
    v_pk_add_f32 v[216:217], v[216:217], v[218:219]
    v_cvt_pk_bf16_f32 v220, v216, v217
    v_lshlrev_b32 v216, 16, v220
    v_and_b32 v217, s94, v220
    v_pk_mul_f32 v[218:219], v[198:199], v[184:185]
    v_cvt_pk_bf16_f32 v220, v218, v219
    v_lshlrev_b32 v218, 16, v220
    v_and_b32 v219, s94, v220
    v_pk_add_f32 v[216:217], v[216:217], v[218:219]
    v_cvt_pk_bf16_f32 v220, v216, v217
    v_lshlrev_b32 v216, 16, v220
    v_and_b32 v217, s94, v220
    v_lshlrev_b32 v218, 16, v160
    v_and_b32 v219, s94, v160
    v_pk_mul_f32 v[216:217], v[216:217], v[218:219]
    v_cvt_pk_bf16_f32 v224, v216, v217
    v_pk_mul_f32 v[216:217], v[194:195], v[190:191]
    v_cvt_pk_bf16_f32 v220, v216, v217
    v_lshlrev_b32 v216, 16, v220
    v_and_b32 v217, s94, v220
    v_pk_mul_f32 v[218:219], v[196:197], v[188:189]
    v_cvt_pk_bf16_f32 v220, v218, v219
    v_lshlrev_b32 v218, 16, v220
    v_and_b32 v219, s94, v220
    v_pk_add_f32 v[216:217], v[216:217], v[218:219]
    v_cvt_pk_bf16_f32 v220, v216, v217
    v_lshlrev_b32 v216, 16, v220
    v_and_b32 v217, s94, v220
    v_pk_mul_f32 v[218:219], v[198:199], v[186:187]
    v_cvt_pk_bf16_f32 v220, v218, v219
    v_lshlrev_b32 v218, 16, v220
    v_and_b32 v219, s94, v220
    v_pk_add_f32 v[216:217], v[216:217], v[218:219]
    v_cvt_pk_bf16_f32 v220, v216, v217
    v_lshlrev_b32 v216, 16, v220
    v_and_b32 v217, s94, v220
    v_pk_mul_f32 v[218:219], v[200:201], v[184:185]
    v_cvt_pk_bf16_f32 v220, v218, v219
    v_lshlrev_b32 v218, 16, v220
    v_and_b32 v219, s94, v220
    v_pk_add_f32 v[216:217], v[216:217], v[218:219]
    v_cvt_pk_bf16_f32 v220, v216, v217
    v_lshlrev_b32 v216, 16, v220
    v_and_b32 v217, s94, v220
    v_lshlrev_b32 v218, 16, v161
    v_and_b32 v219, s94, v161
    v_pk_mul_f32 v[216:217], v[216:217], v[218:219]
    v_cvt_pk_bf16_f32 v225, v216, v217
    v_pk_mul_f32 v[216:217], v[196:197], v[190:191]
    v_cvt_pk_bf16_f32 v220, v216, v217
    v_lshlrev_b32 v216, 16, v220
    v_and_b32 v217, s94, v220
    v_pk_mul_f32 v[218:219], v[198:199], v[188:189]
    v_cvt_pk_bf16_f32 v220, v218, v219
    v_lshlrev_b32 v218, 16, v220
    v_and_b32 v219, s94, v220
    v_pk_add_f32 v[216:217], v[216:217], v[218:219]
    v_cvt_pk_bf16_f32 v220, v216, v217
    v_lshlrev_b32 v216, 16, v220
    v_and_b32 v217, s94, v220
    v_pk_mul_f32 v[218:219], v[200:201], v[186:187]
    v_cvt_pk_bf16_f32 v220, v218, v219
    v_lshlrev_b32 v218, 16, v220
    v_and_b32 v219, s94, v220
    v_pk_add_f32 v[216:217], v[216:217], v[218:219]
    v_cvt_pk_bf16_f32 v220, v216, v217
    v_lshlrev_b32 v216, 16, v220
    v_and_b32 v217, s94, v220
    v_pk_mul_f32 v[218:219], v[202:203], v[184:185]
    v_cvt_pk_bf16_f32 v220, v218, v219
    v_lshlrev_b32 v218, 16, v220
    v_and_b32 v219, s94, v220
    v_pk_add_f32 v[216:217], v[216:217], v[218:219]
    v_cvt_pk_bf16_f32 v220, v216, v217
    v_lshlrev_b32 v216, 16, v220
    v_and_b32 v217, s94, v220
    v_lshlrev_b32 v218, 16, v162
    v_and_b32 v219, s94, v162
    v_pk_mul_f32 v[216:217], v[216:217], v[218:219]
    v_cvt_pk_bf16_f32 v226, v216, v217
    v_pk_mul_f32 v[216:217], v[198:199], v[190:191]
    v_cvt_pk_bf16_f32 v220, v216, v217
    v_lshlrev_b32 v216, 16, v220
    v_and_b32 v217, s94, v220
    v_pk_mul_f32 v[218:219], v[200:201], v[188:189]
    v_cvt_pk_bf16_f32 v220, v218, v219
    v_lshlrev_b32 v218, 16, v220
    v_and_b32 v219, s94, v220
    v_pk_add_f32 v[216:217], v[216:217], v[218:219]
    v_cvt_pk_bf16_f32 v220, v216, v217
    v_lshlrev_b32 v216, 16, v220
    v_and_b32 v217, s94, v220
    v_pk_mul_f32 v[218:219], v[202:203], v[186:187]
    v_cvt_pk_bf16_f32 v220, v218, v219
    v_lshlrev_b32 v218, 16, v220
    v_and_b32 v219, s94, v220
    v_pk_add_f32 v[216:217], v[216:217], v[218:219]
    v_cvt_pk_bf16_f32 v220, v216, v217
    v_lshlrev_b32 v216, 16, v220
    v_and_b32 v217, s94, v220
    v_pk_mul_f32 v[218:219], v[204:205], v[184:185]
    v_cvt_pk_bf16_f32 v220, v218, v219
    v_lshlrev_b32 v218, 16, v220
    v_and_b32 v219, s94, v220
    v_pk_add_f32 v[216:217], v[216:217], v[218:219]
    v_cvt_pk_bf16_f32 v220, v216, v217
    v_lshlrev_b32 v216, 16, v220
    v_and_b32 v217, s94, v220
    v_lshlrev_b32 v218, 16, v163
    v_and_b32 v219, s94, v163
    v_pk_mul_f32 v[216:217], v[216:217], v[218:219]
    v_cvt_pk_bf16_f32 v227, v216, v217
    v_pk_mul_f32 v[216:217], v[200:201], v[190:191]
    v_cvt_pk_bf16_f32 v220, v216, v217
    v_lshlrev_b32 v216, 16, v220
    v_and_b32 v217, s94, v220
    v_pk_mul_f32 v[218:219], v[202:203], v[188:189]
    v_cvt_pk_bf16_f32 v220, v218, v219
    v_lshlrev_b32 v218, 16, v220
    v_and_b32 v219, s94, v220
    v_pk_add_f32 v[216:217], v[216:217], v[218:219]
    v_cvt_pk_bf16_f32 v220, v216, v217
    v_lshlrev_b32 v216, 16, v220
    v_and_b32 v217, s94, v220
    v_pk_mul_f32 v[218:219], v[204:205], v[186:187]
    v_cvt_pk_bf16_f32 v220, v218, v219
    v_lshlrev_b32 v218, 16, v220
    v_and_b32 v219, s94, v220
    v_pk_add_f32 v[216:217], v[216:217], v[218:219]
    v_cvt_pk_bf16_f32 v220, v216, v217
    v_lshlrev_b32 v216, 16, v220
    v_and_b32 v217, s94, v220
    v_pk_mul_f32 v[218:219], v[206:207], v[184:185]
    v_cvt_pk_bf16_f32 v220, v218, v219
    v_lshlrev_b32 v218, 16, v220
    v_and_b32 v219, s94, v220
    v_pk_add_f32 v[216:217], v[216:217], v[218:219]
    v_cvt_pk_bf16_f32 v220, v216, v217
    v_lshlrev_b32 v216, 16, v220
    v_and_b32 v217, s94, v220
    v_lshlrev_b32 v218, 16, v164
    v_and_b32 v219, s94, v164
    v_pk_mul_f32 v[216:217], v[216:217], v[218:219]
    v_cvt_pk_bf16_f32 v228, v216, v217
    v_pk_mul_f32 v[216:217], v[202:203], v[190:191]
    v_cvt_pk_bf16_f32 v220, v216, v217
    v_lshlrev_b32 v216, 16, v220
    v_and_b32 v217, s94, v220
    v_pk_mul_f32 v[218:219], v[204:205], v[188:189]
    v_cvt_pk_bf16_f32 v220, v218, v219
    v_lshlrev_b32 v218, 16, v220
    v_and_b32 v219, s94, v220
    v_pk_add_f32 v[216:217], v[216:217], v[218:219]
    v_cvt_pk_bf16_f32 v220, v216, v217
    v_lshlrev_b32 v216, 16, v220
    v_and_b32 v217, s94, v220
    v_pk_mul_f32 v[218:219], v[206:207], v[186:187]
    v_cvt_pk_bf16_f32 v220, v218, v219
    v_lshlrev_b32 v218, 16, v220
    v_and_b32 v219, s94, v220
    v_pk_add_f32 v[216:217], v[216:217], v[218:219]
    v_cvt_pk_bf16_f32 v220, v216, v217
    v_lshlrev_b32 v216, 16, v220
    v_and_b32 v217, s94, v220
    v_pk_mul_f32 v[218:219], v[208:209], v[184:185]
    v_cvt_pk_bf16_f32 v220, v218, v219
    v_lshlrev_b32 v218, 16, v220
    v_and_b32 v219, s94, v220
    v_pk_add_f32 v[216:217], v[216:217], v[218:219]
    v_cvt_pk_bf16_f32 v220, v216, v217
    v_lshlrev_b32 v216, 16, v220
    v_and_b32 v217, s94, v220
    v_lshlrev_b32 v218, 16, v165
    v_and_b32 v219, s94, v165
    v_pk_mul_f32 v[216:217], v[216:217], v[218:219]
    v_cvt_pk_bf16_f32 v229, v216, v217
    v_pk_mul_f32 v[216:217], v[204:205], v[190:191]
    v_cvt_pk_bf16_f32 v220, v216, v217
    v_lshlrev_b32 v216, 16, v220
    v_and_b32 v217, s94, v220
    v_pk_mul_f32 v[218:219], v[206:207], v[188:189]
    v_cvt_pk_bf16_f32 v220, v218, v219
    v_lshlrev_b32 v218, 16, v220
    v_and_b32 v219, s94, v220
    v_pk_add_f32 v[216:217], v[216:217], v[218:219]
    v_cvt_pk_bf16_f32 v220, v216, v217
    v_lshlrev_b32 v216, 16, v220
    v_and_b32 v217, s94, v220
    v_pk_mul_f32 v[218:219], v[208:209], v[186:187]
    v_cvt_pk_bf16_f32 v220, v218, v219
    v_lshlrev_b32 v218, 16, v220
    v_and_b32 v219, s94, v220
    v_pk_add_f32 v[216:217], v[216:217], v[218:219]
    v_cvt_pk_bf16_f32 v220, v216, v217
    v_lshlrev_b32 v216, 16, v220
    v_and_b32 v217, s94, v220
    v_pk_mul_f32 v[218:219], v[210:211], v[184:185]
    v_cvt_pk_bf16_f32 v220, v218, v219
    v_lshlrev_b32 v218, 16, v220
    v_and_b32 v219, s94, v220
    v_pk_add_f32 v[216:217], v[216:217], v[218:219]
    v_cvt_pk_bf16_f32 v220, v216, v217
    v_lshlrev_b32 v216, 16, v220
    v_and_b32 v217, s94, v220
    v_lshlrev_b32 v218, 16, v166
    v_and_b32 v219, s94, v166
    v_pk_mul_f32 v[216:217], v[216:217], v[218:219]
    v_cvt_pk_bf16_f32 v230, v216, v217
    v_pk_mul_f32 v[216:217], v[206:207], v[190:191]
    v_cvt_pk_bf16_f32 v220, v216, v217
    v_lshlrev_b32 v216, 16, v220
    v_and_b32 v217, s94, v220
    v_pk_mul_f32 v[218:219], v[208:209], v[188:189]
    v_cvt_pk_bf16_f32 v220, v218, v219
    v_lshlrev_b32 v218, 16, v220
    v_and_b32 v219, s94, v220
    v_pk_add_f32 v[216:217], v[216:217], v[218:219]
    v_cvt_pk_bf16_f32 v220, v216, v217
    v_lshlrev_b32 v216, 16, v220
    v_and_b32 v217, s94, v220
    v_pk_mul_f32 v[218:219], v[210:211], v[186:187]
    v_cvt_pk_bf16_f32 v220, v218, v219
    v_lshlrev_b32 v218, 16, v220
    v_and_b32 v219, s94, v220
    v_pk_add_f32 v[216:217], v[216:217], v[218:219]
    v_cvt_pk_bf16_f32 v220, v216, v217
    v_lshlrev_b32 v216, 16, v220
    v_and_b32 v217, s94, v220
    v_pk_mul_f32 v[218:219], v[212:213], v[184:185]
    v_cvt_pk_bf16_f32 v220, v218, v219
    v_lshlrev_b32 v218, 16, v220
    v_and_b32 v219, s94, v220
    v_pk_add_f32 v[216:217], v[216:217], v[218:219]
    v_cvt_pk_bf16_f32 v220, v216, v217
    v_lshlrev_b32 v216, 16, v220
    v_and_b32 v217, s94, v220
    v_lshlrev_b32 v218, 16, v167
    v_and_b32 v219, s94, v167
    v_pk_mul_f32 v[216:217], v[216:217], v[218:219]
    v_cvt_pk_bf16_f32 v231, v216, v217
    v_perm_b32 v232, v230, v231, s95
    v_perm_b32 v236, v230, v231, s96
    v_perm_b32 v233, v228, v229, s95
    v_perm_b32 v237, v228, v229, s96
    v_perm_b32 v234, v226, v227, s95
    v_perm_b32 v238, v226, v227, s96
    v_perm_b32 v235, v224, v225, s95
    v_perm_b32 v239, v224, v225, s96
    v_mul_u32_u24 v144, 288, v129
    v_lshlrev_b32 v145, 4, v130
    v_sub_u32 v144, v144, v145
    v_add_u32 v144, 112, v144
    ds_write_b128 v144, v[232:235] offset:59392
    ds_write_b128 v144, v[236:239] offset:59536
    v_lshrrev_b32 v145, 3, v0
    s_lshl_b32 s97, s20, 4
    v_add_u32 v145, s97, v145
    v_and_b32 v146, 7, v0
    v_lshlrev_b32 v146, 4, v146
    v_mul_u32_u24 v147, 144, v145
    v_add_u32 v147, v147, v146
    s_and_b32 s97, s2, 7
    s_lshl_b32 s97, s97, 18
    s_lshr_b32 s98, s2, 3
    s_lshl_b32 s98, s98, 7
    s_sub_u32 s97, s97, s98
    s_add_u32 s97, s97, 3968
    v_lshl_add_u32 v148, v145, 12, v146
    s_waitcnt lgkmcnt(0)
    s_barrier
    ds_read_b128 v[232:235], v147 offset:59392
    ds_read_b128 v[236:239], v147 offset:60544
    s_add_u32 s98, s97, 32768
    s_waitcnt lgkmcnt(1)
    buffer_store_dwordx4 v[232:235], v148, s[76:79], s97 offen sc1
    s_waitcnt lgkmcnt(0)
    buffer_store_dwordx4 v[236:239], v148, s[76:79], s98 offen sc1
    v_mov_b32 v8, 0
    v_mov_b32 v9, 0
    v_mov_b32 v10, 0
    v_mov_b32 v11, 0
    v_add_u32 v7, s28, v1
    v_cmp_gt_u32 vcc, 32, v0
    s_and_saveexec_b64 s[52:53], vcc
    ds_write_b128 v7, v[8:11] offset:20736
    s_mov_b64 exec, s[52:53]
    v_add_u32 v7, s29, v7
    s_waitcnt vmcnt(0) lgkmcnt(0)
    s_barrier
    s_cmp_lg_u32 s20, 0
    s_cbranch_scc1 B_NOSIG
B_N1:
    v_mov_b32 v15, 0
    buffer_load_dwordx2 v[14:15], v15, s[48:51], 0 offen sc1
    s_waitcnt vmcnt(0)
    v_readfirstlane_b32 s54, v14
    s_cmp_lg_u32 s54, 0
    s_cbranch_scc1 B_N1_OK
    s_sleep 4
    s_branch B_N1
B_N1_OK:
    s_lshl_b32 s54, s2, 7
    s_add_u32 s54, s54, 32768
    v_mov_b32 v8, s54
    s_mov_b64 exec, 1
    buffer_store_dwordx2 v[14:15], v8, s[60:63], 0 offen sc1
    s_mov_b64 exec, -1
B_NOSIG:
    v_lshlrev_b32 v240, 16, v180
    v_and_b32 v241, s94, v180
    v_lshlrev_b32 v242, 16, v181
    v_and_b32 v243, s94, v181
    v_lshlrev_b32 v244, 16, v182
    v_and_b32 v245, s94, v182
    v_lshlrev_b32 v246, 16, v183
    v_and_b32 v247, s94, v183
    v_lshlrev_b32 v250, 16, v172
    v_and_b32 v251, s94, v172
    v_pk_mul_f32 v[250:251], v[250:251], v[240:241]
    v_cvt_pk_bf16_f32 v252, v250, v251
    v_lshlrev_b32 v250, 16, v252
    v_and_b32 v251, s94, v252
    v_add_f32 v248, v250, v251
    v_lshlrev_b32 v250, 16, v173
    v_and_b32 v251, s94, v173
    v_pk_mul_f32 v[250:251], v[250:251], v[242:243]
    v_cvt_pk_bf16_f32 v252, v250, v251
    v_lshlrev_b32 v250, 16, v252
    v_and_b32 v251, s94, v252
    v_add_f32 v248, v248, v250
    v_add_f32 v248, v248, v251
    v_lshlrev_b32 v250, 16, v174
    v_and_b32 v251, s94, v174
    v_pk_mul_f32 v[250:251], v[250:251], v[244:245]
    v_cvt_pk_bf16_f32 v252, v250, v251
    v_lshlrev_b32 v250, 16, v252
    v_and_b32 v251, s94, v252
    v_add_f32 v248, v248, v250
    v_add_f32 v248, v248, v251
    v_lshlrev_b32 v250, 16, v175
    v_and_b32 v251, s94, v175
    v_pk_mul_f32 v[250:251], v[250:251], v[246:247]
    v_cvt_pk_bf16_f32 v252, v250, v251
    v_lshlrev_b32 v250, 16, v252
    v_and_b32 v251, s94, v252
    v_add_f32 v248, v248, v250
    v_add_f32 v248, v248, v251
    v_lshlrev_b32 v250, 16, v176
    v_and_b32 v251, s94, v176
    v_pk_mul_f32 v[250:251], v[250:251], v[240:241]
    v_cvt_pk_bf16_f32 v252, v250, v251
    v_lshlrev_b32 v250, 16, v252
    v_and_b32 v251, s94, v252
    v_add_f32 v249, v250, v251
    v_lshlrev_b32 v250, 16, v177
    v_and_b32 v251, s94, v177
    v_pk_mul_f32 v[250:251], v[250:251], v[242:243]
    v_cvt_pk_bf16_f32 v252, v250, v251
    v_lshlrev_b32 v250, 16, v252
    v_and_b32 v251, s94, v252
    v_add_f32 v249, v249, v250
    v_add_f32 v249, v249, v251
    v_lshlrev_b32 v250, 16, v178
    v_and_b32 v251, s94, v178
    v_pk_mul_f32 v[250:251], v[250:251], v[244:245]
    v_cvt_pk_bf16_f32 v252, v250, v251
    v_lshlrev_b32 v250, 16, v252
    v_and_b32 v251, s94, v252
    v_add_f32 v249, v249, v250
    v_add_f32 v249, v249, v251
    v_lshlrev_b32 v250, 16, v179
    v_and_b32 v251, s94, v179
    v_pk_mul_f32 v[250:251], v[250:251], v[246:247]
    v_cvt_pk_bf16_f32 v252, v250, v251
    v_lshlrev_b32 v250, 16, v252
    v_and_b32 v251, s94, v252
    v_add_f32 v249, v249, v250
    v_add_f32 v249, v249, v251
    s_nop 1
    v_add_f32_dpp v248, v248, v248 row_shr:1 bound_ctrl:0
    v_add_f32_dpp v249, v249, v249 row_shr:1 bound_ctrl:0
    s_nop 1
    v_add_f32_dpp v248, v248, v248 row_shr:2 bound_ctrl:0
    v_add_f32_dpp v249, v249, v249 row_shr:2 bound_ctrl:0
    s_nop 1
    v_add_f32_dpp v248, v248, v248 row_shr:4 bound_ctrl:0
    v_add_f32_dpp v249, v249, v249 row_shr:4 bound_ctrl:0
    s_nop 1
    v_add_f32_dpp v248, v248, v248 row_shr:8 bound_ctrl:0
    v_add_f32_dpp v249, v249, v249 row_shr:8 bound_ctrl:0
    s_nop 1
    v_add_f32_dpp v248, v248, v248 row_bcast:15 row_mask:0xa
    v_add_f32_dpp v249, v249, v249 row_bcast:15 row_mask:0xa
    s_nop 1
    v_add_f32_dpp v248, v248, v248 row_bcast:31 row_mask:0xc
    v_add_f32_dpp v249, v249, v249 row_bcast:31 row_mask:0xc
    s_nop 1
    v_readlane_b32 s98, v248, 63
    v_readlane_b32 s99, v249, 63
    s_nop 3
    v_mov_b32 v248, s98
    v_mov_b32 v249, s99
    v_cvt_pk_bf16_f32 v252, v248, v249
    v_lshlrev_b32 v248, 16, v252
    v_and_b32 v249, s94, v252
    v_mul_f32 v248, 0xbfb8aa3b, v248
    v_mul_f32 v249, 0xbfb8aa3b, v249
    v_exp_f32 v248, v248
    v_exp_f32 v249, v249
    s_nop 0
    v_add_f32 v248, 1.0, v248
    v_add_f32 v249, 1.0, v249
    v_rcp_f32 v248, v248
    v_rcp_f32 v249, v249
    s_nop 0
    v_cvt_pk_bf16_f32 v252, v248, v249
    v_lshlrev_b32 v248, 16, v252
    v_and_b32 v249, s94, v252
    s_lshl_b32 s93, s92, 2
    v_mov_b32 v250, s93
    v_cmp_eq_u32 vcc, 0, v0
    s_and_saveexec_b64 s[98:99], vcc
    buffer_store_dwordx2 v[248:249], v250, s[88:91], 0 offen sc1
    s_mov_b64 exec, s[98:99]
    s_mov_b32 s52, s58
    s_mov_b32 s53, s59
    s_mov_b32 s54, 0x1c0000
    s_mov_b32 s55, 0x00020000
    v_lshlrev_b32 v2, 7, v0
    buffer_load_dword v200, v2, s[52:55], s21 offen
    s_add_u32 s21, s21, 1048576
    buffer_load_dword v200, v2, s[52:55], s21 offen
    v_alignbit_b32 v48, v17, v16, 16
    v_alignbit_b32 v49, v18, v17, 16
    v_alignbit_b32 v50, v19, v18, 16
    v_alignbit_b32 v51, v20, v19, 16
    v_alignbit_b32 v52, v21, v20, 16
    v_mov_b32 v56, v49
    v_mov_b32 v60, v17
    v_mov_b32 v57, v50
    v_mov_b32 v61, v18
    v_mov_b32 v58, v51
    v_mov_b32 v62, v19
    v_mov_b32 v59, v52
    v_mov_b32 v63, v20
    ds_write_b128 v7, v[48:51] offset:0
    ds_write_b128 v7, v[60:63] offset:4160
    ds_write_b128 v7, v[56:59] offset:8320
    ds_write_b128 v7, v[18:21] offset:12480
    v_alignbit_b32 v48, v25, v24, 16
    v_alignbit_b32 v49, v26, v25, 16
    v_alignbit_b32 v50, v27, v26, 16
    v_alignbit_b32 v51, v28, v27, 16
    v_alignbit_b32 v52, v29, v28, 16
    v_mov_b32 v56, v49
    v_mov_b32 v60, v25
    v_mov_b32 v57, v50
    v_mov_b32 v61, v26
    v_mov_b32 v58, v51
    v_mov_b32 v62, v27
    v_mov_b32 v59, v52
    v_mov_b32 v63, v28
    ds_write_b128 v7, v[48:51] offset:2048
    ds_write_b128 v7, v[60:63] offset:6208
    ds_write_b128 v7, v[56:59] offset:10368
    ds_write_b128 v7, v[26:29] offset:14528
    s_lshl_b32 s54, s25, 6
    v_add_u32 v12, s54, v0
    v_cmp_gt_u32 vcc, 4, v12
    s_and_saveexec_b64 s[52:53], vcc
    s_cbranch_execz CV_SKIPK
    v_alignbit_b32 v48, v33, v32, 16
    v_alignbit_b32 v49, v34, v33, 16
    v_alignbit_b32 v50, v35, v34, 16
    v_alignbit_b32 v51, v36, v35, 16
    v_alignbit_b32 v52, v37, v36, 16
    v_mov_b32 v56, v49
    v_mov_b32 v60, v33
    v_mov_b32 v57, v50
    v_mov_b32 v61, v34
    v_mov_b32 v58, v51
    v_mov_b32 v62, v35
    v_mov_b32 v59, v52
    v_mov_b32 v63, v36
    ds_write_b128 v7, v[48:51] offset:4096
    ds_write_b128 v7, v[60:63] offset:8256
    ds_write_b128 v7, v[56:59] offset:12416
    ds_write_b128 v7, v[34:37] offset:16576
CV_SKIPK:
    s_mov_b64 exec, s[52:53]
    v_and_b32 v4, 15, v0
    v_lshrrev_b32 v5, 4, v0
    v_and_b32 v6, 3, v0
    s_movk_i32 s54, 4160
    v_mul_lo_u32 v6, v6, s54
    v_lshl_add_u32 v6, v5, 4, v6
    v_and_b32 v8, 12, v0
    v_lshl_add_u32 v6, v8, 1, v6
    s_lshl_b32 s54, s25, 8
    s_add_u32 s54, s54, s28
    v_add_u32 v6, s54, v6
    v_lshlrev_b32 v8, 5, v4
    v_lshlrev_b32 v9, 4, v5
    v_sub_u32 v8, v9, v8
    s_add_u32 s54, s54, 17120
    v_add_u32 v8, s54, v8
    v_mov_b32 v224, 0
    v_mov_b32 v225, 0
    v_mov_b32 v226, 0
    v_mov_b32 v227, 0
    v_mov_b32 v228, 0
    v_mov_b32 v229, 0
    v_mov_b32 v230, 0
    v_mov_b32 v231, 0
    v_mov_b32 v232, 0
    v_mov_b32 v233, 0
    v_mov_b32 v234, 0
    v_mov_b32 v235, 0
    v_mov_b32 v236, 0
    v_mov_b32 v237, 0
    v_mov_b32 v238, 0
    v_mov_b32 v239, 0
    v_mov_b32 v240, 0
    v_mov_b32 v241, 0
    v_mov_b32 v242, 0
    v_mov_b32 v243, 0
    v_mov_b32 v244, 0
    v_mov_b32 v245, 0
    v_mov_b32 v246, 0
    v_mov_b32 v247, 0
    v_mov_b32 v248, 0
    v_mov_b32 v249, 0
    v_mov_b32 v250, 0
    v_mov_b32 v251, 0
    v_mov_b32 v252, 0
    v_mov_b32 v253, 0
    v_mov_b32 v254, 0
    v_mov_b32 v255, 0
    v_and_b32 v10, 31, v0
    v_lshlrev_b32 v10, 3, v10
    s_and_b32 s54, s2, 7
    v_add_u32 v10, s54, v10
    v_lshlrev_b32 v10, 7, v10
    v_add_u32 v10, 32768, v10
    s_cmp_lg_u32 s20, 0
    s_cbranch_scc1 B_UG
B_UP:
    buffer_load_dwordx2 v[48:49], v10, s[60:63], 0 offen sc1
    s_waitcnt vmcnt(0)
    v_cmp_ne_u32 vcc, v48, v14
    v_cmp_ne_u32 s[54:55], v49, v15
    s_nop 1
    s_or_b64 vcc, vcc, s[54:55]
    s_cmp_eq_u64 vcc, 0
    s_cbranch_scc1 B_UG
    s_sleep 8
    s_branch B_UP
B_UG:
    s_barrier
    s_lshl_b32 s29, s25, 11
    s_add_u32 s30, s27, s29
    s_add_u32 s31, s28, s29
    s_add_u32 m0, s31, 16640
    s_nop 0
    buffer_load_dwordx4 v1, s[36:39], s30 offen sc1 lds
    buffer_load_dwordx4 v1, s[36:39], s30 offen offset:1024 sc1 lds
    s_waitcnt vmcnt(0) lgkmcnt(0)
    s_barrier
    ds_read_b128 v[96:99], v8 offset:3584
    ds_read_b64 v[64:65], v6 offset:0
    ds_read_b64 v[66:67], v6 offset:8
    ds_read_b128 v[100:103], v8 offset:3072
    ds_read_b64 v[68:69], v6 offset:512
    ds_read_b64 v[70:71], v6 offset:520
    ds_read_b128 v[104:107], v8 offset:2560
    ds_read_b64 v[72:73], v6 offset:1024
    ds_read_b64 v[74:75], v6 offset:1032
    ds_read_b128 v[108:111], v8 offset:2048
    ds_read_b64 v[76:77], v6 offset:1536
    ds_read_b64 v[78:79], v6 offset:1544
    ds_read_b128 v[112:115], v8 offset:1536
    ds_read_b64 v[80:81], v6 offset:2048
    ds_read_b64 v[82:83], v6 offset:2056
    ds_read_b128 v[116:119], v8 offset:1024
    ds_read_b64 v[84:85], v6 offset:2560
    ds_read_b64 v[86:87], v6 offset:2568
    ds_read_b128 v[120:123], v8 offset:512
    ds_read_b64 v[88:89], v6 offset:3072
    ds_read_b64 v[90:91], v6 offset:3080
    ds_read_b128 v[124:127], v8 offset:0
    ds_read_b64 v[92:93], v6 offset:3584
    ds_read_b64 v[94:95], v6 offset:3592
    s_waitcnt lgkmcnt(0)
    v_mfma_f32_16x16x32_bf16 v[224:227], v[64:67], v[96:99], v[224:227]
    ds_read_b128 v[160:163], v8 offset:3648
    v_mfma_f32_16x16x32_bf16 v[228:231], v[64:67], v[100:103], v[228:231]
    ds_read_b64 v[128:129], v6 offset:64
    v_mfma_f32_16x16x32_bf16 v[228:231], v[68:71], v[96:99], v[228:231]
    ds_read_b64 v[130:131], v6 offset:72
    v_mfma_f32_16x16x32_bf16 v[232:235], v[64:67], v[104:107], v[232:235]
    ds_read_b128 v[164:167], v8 offset:3136
    v_mfma_f32_16x16x32_bf16 v[232:235], v[68:71], v[100:103], v[232:235]
    ds_read_b64 v[132:133], v6 offset:576
    v_mfma_f32_16x16x32_bf16 v[232:235], v[72:75], v[96:99], v[232:235]
    ds_read_b64 v[134:135], v6 offset:584
    v_mfma_f32_16x16x32_bf16 v[236:239], v[64:67], v[108:111], v[236:239]
    ds_read_b128 v[168:171], v8 offset:2624
    v_mfma_f32_16x16x32_bf16 v[236:239], v[68:71], v[104:107], v[236:239]
    ds_read_b64 v[136:137], v6 offset:1088
    v_mfma_f32_16x16x32_bf16 v[236:239], v[72:75], v[100:103], v[236:239]
    ds_read_b64 v[138:139], v6 offset:1096
    v_mfma_f32_16x16x32_bf16 v[236:239], v[76:79], v[96:99], v[236:239]
    ds_read_b128 v[172:175], v8 offset:2112
    v_mfma_f32_16x16x32_bf16 v[240:243], v[64:67], v[112:115], v[240:243]
    ds_read_b64 v[140:141], v6 offset:1600
    v_mfma_f32_16x16x32_bf16 v[240:243], v[68:71], v[108:111], v[240:243]
    ds_read_b64 v[142:143], v6 offset:1608
    v_mfma_f32_16x16x32_bf16 v[240:243], v[72:75], v[104:107], v[240:243]
    ds_read_b128 v[176:179], v8 offset:1600
    v_mfma_f32_16x16x32_bf16 v[240:243], v[76:79], v[100:103], v[240:243]
    ds_read_b64 v[144:145], v6 offset:2112
    v_mfma_f32_16x16x32_bf16 v[240:243], v[80:83], v[96:99], v[240:243]
    ds_read_b64 v[146:147], v6 offset:2120
    v_mfma_f32_16x16x32_bf16 v[244:247], v[64:67], v[116:119], v[244:247]
    ds_read_b128 v[180:183], v8 offset:1088
    v_mfma_f32_16x16x32_bf16 v[244:247], v[68:71], v[112:115], v[244:247]
    ds_read_b64 v[148:149], v6 offset:2624
    v_mfma_f32_16x16x32_bf16 v[244:247], v[72:75], v[108:111], v[244:247]
    ds_read_b64 v[150:151], v6 offset:2632
    v_mfma_f32_16x16x32_bf16 v[244:247], v[76:79], v[104:107], v[244:247]
    ds_read_b128 v[184:187], v8 offset:576
    v_mfma_f32_16x16x32_bf16 v[244:247], v[80:83], v[100:103], v[244:247]
    ds_read_b64 v[152:153], v6 offset:3136
    v_mfma_f32_16x16x32_bf16 v[244:247], v[84:87], v[96:99], v[244:247]
    ds_read_b64 v[154:155], v6 offset:3144
    v_mfma_f32_16x16x32_bf16 v[248:251], v[64:67], v[120:123], v[248:251]
    ds_read_b128 v[188:191], v8 offset:64
    v_mfma_f32_16x16x32_bf16 v[248:251], v[68:71], v[116:119], v[248:251]
    ds_read_b64 v[156:157], v6 offset:3648
    v_mfma_f32_16x16x32_bf16 v[248:251], v[72:75], v[112:115], v[248:251]
    ds_read_b64 v[158:159], v6 offset:3656
    v_mfma_f32_16x16x32_bf16 v[248:251], v[76:79], v[108:111], v[248:251]
    v_mfma_f32_16x16x32_bf16 v[248:251], v[80:83], v[104:107], v[248:251]
    v_mfma_f32_16x16x32_bf16 v[248:251], v[84:87], v[100:103], v[248:251]
    v_mfma_f32_16x16x32_bf16 v[248:251], v[88:91], v[96:99], v[248:251]
    v_mfma_f32_16x16x32_bf16 v[252:255], v[64:67], v[124:127], v[252:255]
    v_mfma_f32_16x16x32_bf16 v[252:255], v[68:71], v[120:123], v[252:255]
    v_mfma_f32_16x16x32_bf16 v[252:255], v[72:75], v[116:119], v[252:255]
    v_mfma_f32_16x16x32_bf16 v[252:255], v[76:79], v[112:115], v[252:255]
    v_mfma_f32_16x16x32_bf16 v[252:255], v[80:83], v[108:111], v[252:255]
    v_mfma_f32_16x16x32_bf16 v[252:255], v[84:87], v[104:107], v[252:255]
    v_mfma_f32_16x16x32_bf16 v[252:255], v[88:91], v[100:103], v[252:255]
    v_mfma_f32_16x16x32_bf16 v[252:255], v[92:95], v[96:99], v[252:255]
    s_waitcnt lgkmcnt(0)
    v_mfma_f32_16x16x32_bf16 v[224:227], v[128:131], v[160:163], v[224:227]
    ds_read_b128 v[96:99], v8 offset:3712
    v_mfma_f32_16x16x32_bf16 v[228:231], v[128:131], v[164:167], v[228:231]
    ds_read_b64 v[64:65], v6 offset:128
    v_mfma_f32_16x16x32_bf16 v[228:231], v[132:135], v[160:163], v[228:231]
    ds_read_b64 v[66:67], v6 offset:136
    v_mfma_f32_16x16x32_bf16 v[232:235], v[128:131], v[168:171], v[232:235]
    ds_read_b128 v[100:103], v8 offset:3200
    v_mfma_f32_16x16x32_bf16 v[232:235], v[132:135], v[164:167], v[232:235]
    ds_read_b64 v[68:69], v6 offset:640
    v_mfma_f32_16x16x32_bf16 v[232:235], v[136:139], v[160:163], v[232:235]
    ds_read_b64 v[70:71], v6 offset:648
    v_mfma_f32_16x16x32_bf16 v[236:239], v[128:131], v[172:175], v[236:239]
    ds_read_b128 v[104:107], v8 offset:2688
    v_mfma_f32_16x16x32_bf16 v[236:239], v[132:135], v[168:171], v[236:239]
    ds_read_b64 v[72:73], v6 offset:1152
    v_mfma_f32_16x16x32_bf16 v[236:239], v[136:139], v[164:167], v[236:239]
    ds_read_b64 v[74:75], v6 offset:1160
    v_mfma_f32_16x16x32_bf16 v[236:239], v[140:143], v[160:163], v[236:239]
    ds_read_b128 v[108:111], v8 offset:2176
    v_mfma_f32_16x16x32_bf16 v[240:243], v[128:131], v[176:179], v[240:243]
    ds_read_b64 v[76:77], v6 offset:1664
    v_mfma_f32_16x16x32_bf16 v[240:243], v[132:135], v[172:175], v[240:243]
    ds_read_b64 v[78:79], v6 offset:1672
    v_mfma_f32_16x16x32_bf16 v[240:243], v[136:139], v[168:171], v[240:243]
    ds_read_b128 v[112:115], v8 offset:1664
    v_mfma_f32_16x16x32_bf16 v[240:243], v[140:143], v[164:167], v[240:243]
    ds_read_b64 v[80:81], v6 offset:2176
    v_mfma_f32_16x16x32_bf16 v[240:243], v[144:147], v[160:163], v[240:243]
    ds_read_b64 v[82:83], v6 offset:2184
    v_mfma_f32_16x16x32_bf16 v[244:247], v[128:131], v[180:183], v[244:247]
    ds_read_b128 v[116:119], v8 offset:1152
    v_mfma_f32_16x16x32_bf16 v[244:247], v[132:135], v[176:179], v[244:247]
    ds_read_b64 v[84:85], v6 offset:2688
    v_mfma_f32_16x16x32_bf16 v[244:247], v[136:139], v[172:175], v[244:247]
    ds_read_b64 v[86:87], v6 offset:2696
    v_mfma_f32_16x16x32_bf16 v[244:247], v[140:143], v[168:171], v[244:247]
    ds_read_b128 v[120:123], v8 offset:640
    v_mfma_f32_16x16x32_bf16 v[244:247], v[144:147], v[164:167], v[244:247]
    ds_read_b64 v[88:89], v6 offset:3200
    v_mfma_f32_16x16x32_bf16 v[244:247], v[148:151], v[160:163], v[244:247]
    ds_read_b64 v[90:91], v6 offset:3208
    v_mfma_f32_16x16x32_bf16 v[248:251], v[128:131], v[184:187], v[248:251]
    ds_read_b128 v[124:127], v8 offset:128
    v_mfma_f32_16x16x32_bf16 v[248:251], v[132:135], v[180:183], v[248:251]
    ds_read_b64 v[92:93], v6 offset:3712
    v_mfma_f32_16x16x32_bf16 v[248:251], v[136:139], v[176:179], v[248:251]
    ds_read_b64 v[94:95], v6 offset:3720
    v_mfma_f32_16x16x32_bf16 v[248:251], v[140:143], v[172:175], v[248:251]
    v_mfma_f32_16x16x32_bf16 v[248:251], v[144:147], v[168:171], v[248:251]
    v_mfma_f32_16x16x32_bf16 v[248:251], v[148:151], v[164:167], v[248:251]
    v_mfma_f32_16x16x32_bf16 v[248:251], v[152:155], v[160:163], v[248:251]
    v_mfma_f32_16x16x32_bf16 v[252:255], v[128:131], v[188:191], v[252:255]
    v_mfma_f32_16x16x32_bf16 v[252:255], v[132:135], v[184:187], v[252:255]
    v_mfma_f32_16x16x32_bf16 v[252:255], v[136:139], v[180:183], v[252:255]
    v_mfma_f32_16x16x32_bf16 v[252:255], v[140:143], v[176:179], v[252:255]
    v_mfma_f32_16x16x32_bf16 v[252:255], v[144:147], v[172:175], v[252:255]
    v_mfma_f32_16x16x32_bf16 v[252:255], v[148:151], v[168:171], v[252:255]
    v_mfma_f32_16x16x32_bf16 v[252:255], v[152:155], v[164:167], v[252:255]
    v_mfma_f32_16x16x32_bf16 v[252:255], v[156:159], v[160:163], v[252:255]
    s_waitcnt lgkmcnt(0)
    v_mfma_f32_16x16x32_bf16 v[224:227], v[64:67], v[96:99], v[224:227]
    ds_read_b128 v[160:163], v8 offset:3776
    v_mfma_f32_16x16x32_bf16 v[228:231], v[64:67], v[100:103], v[228:231]
    ds_read_b64 v[128:129], v6 offset:192
    v_mfma_f32_16x16x32_bf16 v[228:231], v[68:71], v[96:99], v[228:231]
    ds_read_b64 v[130:131], v6 offset:200
    v_mfma_f32_16x16x32_bf16 v[232:235], v[64:67], v[104:107], v[232:235]
    ds_read_b128 v[164:167], v8 offset:3264
    v_mfma_f32_16x16x32_bf16 v[232:235], v[68:71], v[100:103], v[232:235]
    ds_read_b64 v[132:133], v6 offset:704
    v_mfma_f32_16x16x32_bf16 v[232:235], v[72:75], v[96:99], v[232:235]
    ds_read_b64 v[134:135], v6 offset:712
    v_mfma_f32_16x16x32_bf16 v[236:239], v[64:67], v[108:111], v[236:239]
    ds_read_b128 v[168:171], v8 offset:2752
    v_mfma_f32_16x16x32_bf16 v[236:239], v[68:71], v[104:107], v[236:239]
    ds_read_b64 v[136:137], v6 offset:1216
    v_mfma_f32_16x16x32_bf16 v[236:239], v[72:75], v[100:103], v[236:239]
    ds_read_b64 v[138:139], v6 offset:1224
    v_mfma_f32_16x16x32_bf16 v[236:239], v[76:79], v[96:99], v[236:239]
    ds_read_b128 v[172:175], v8 offset:2240
    v_mfma_f32_16x16x32_bf16 v[240:243], v[64:67], v[112:115], v[240:243]
    ds_read_b64 v[140:141], v6 offset:1728
    v_mfma_f32_16x16x32_bf16 v[240:243], v[68:71], v[108:111], v[240:243]
    ds_read_b64 v[142:143], v6 offset:1736
    v_mfma_f32_16x16x32_bf16 v[240:243], v[72:75], v[104:107], v[240:243]
    ds_read_b128 v[176:179], v8 offset:1728
    v_mfma_f32_16x16x32_bf16 v[240:243], v[76:79], v[100:103], v[240:243]
    ds_read_b64 v[144:145], v6 offset:2240
    v_mfma_f32_16x16x32_bf16 v[240:243], v[80:83], v[96:99], v[240:243]
    ds_read_b64 v[146:147], v6 offset:2248
    v_mfma_f32_16x16x32_bf16 v[244:247], v[64:67], v[116:119], v[244:247]
    ds_read_b128 v[180:183], v8 offset:1216
    v_mfma_f32_16x16x32_bf16 v[244:247], v[68:71], v[112:115], v[244:247]
    ds_read_b64 v[148:149], v6 offset:2752
    v_mfma_f32_16x16x32_bf16 v[244:247], v[72:75], v[108:111], v[244:247]
    ds_read_b64 v[150:151], v6 offset:2760
    v_mfma_f32_16x16x32_bf16 v[244:247], v[76:79], v[104:107], v[244:247]
    ds_read_b128 v[184:187], v8 offset:704
    v_mfma_f32_16x16x32_bf16 v[244:247], v[80:83], v[100:103], v[244:247]
    ds_read_b64 v[152:153], v6 offset:3264
    v_mfma_f32_16x16x32_bf16 v[244:247], v[84:87], v[96:99], v[244:247]
    ds_read_b64 v[154:155], v6 offset:3272
    v_mfma_f32_16x16x32_bf16 v[248:251], v[64:67], v[120:123], v[248:251]
    ds_read_b128 v[188:191], v8 offset:192
    v_mfma_f32_16x16x32_bf16 v[248:251], v[68:71], v[116:119], v[248:251]
    ds_read_b64 v[156:157], v6 offset:3776
    v_mfma_f32_16x16x32_bf16 v[248:251], v[72:75], v[112:115], v[248:251]
    ds_read_b64 v[158:159], v6 offset:3784
    v_mfma_f32_16x16x32_bf16 v[248:251], v[76:79], v[108:111], v[248:251]
    v_mfma_f32_16x16x32_bf16 v[248:251], v[80:83], v[104:107], v[248:251]
    v_mfma_f32_16x16x32_bf16 v[248:251], v[84:87], v[100:103], v[248:251]
    v_mfma_f32_16x16x32_bf16 v[248:251], v[88:91], v[96:99], v[248:251]
    v_mfma_f32_16x16x32_bf16 v[252:255], v[64:67], v[124:127], v[252:255]
    v_mfma_f32_16x16x32_bf16 v[252:255], v[68:71], v[120:123], v[252:255]
    v_mfma_f32_16x16x32_bf16 v[252:255], v[72:75], v[116:119], v[252:255]
    v_mfma_f32_16x16x32_bf16 v[252:255], v[76:79], v[112:115], v[252:255]
    v_mfma_f32_16x16x32_bf16 v[252:255], v[80:83], v[108:111], v[252:255]
    v_mfma_f32_16x16x32_bf16 v[252:255], v[84:87], v[104:107], v[252:255]
    v_mfma_f32_16x16x32_bf16 v[252:255], v[88:91], v[100:103], v[252:255]
    v_mfma_f32_16x16x32_bf16 v[252:255], v[92:95], v[96:99], v[252:255]
    s_waitcnt lgkmcnt(0)
    v_mfma_f32_16x16x32_bf16 v[224:227], v[128:131], v[160:163], v[224:227]
    v_mfma_f32_16x16x32_bf16 v[228:231], v[128:131], v[164:167], v[228:231]
    v_mfma_f32_16x16x32_bf16 v[228:231], v[132:135], v[160:163], v[228:231]
    v_mfma_f32_16x16x32_bf16 v[232:235], v[128:131], v[168:171], v[232:235]
    v_mfma_f32_16x16x32_bf16 v[232:235], v[132:135], v[164:167], v[232:235]
    v_mfma_f32_16x16x32_bf16 v[232:235], v[136:139], v[160:163], v[232:235]
    v_mfma_f32_16x16x32_bf16 v[236:239], v[128:131], v[172:175], v[236:239]
    v_mfma_f32_16x16x32_bf16 v[236:239], v[132:135], v[168:171], v[236:239]
    v_mfma_f32_16x16x32_bf16 v[236:239], v[136:139], v[164:167], v[236:239]
    v_mfma_f32_16x16x32_bf16 v[236:239], v[140:143], v[160:163], v[236:239]
    v_mfma_f32_16x16x32_bf16 v[240:243], v[128:131], v[176:179], v[240:243]
    v_mfma_f32_16x16x32_bf16 v[240:243], v[132:135], v[172:175], v[240:243]
    v_mfma_f32_16x16x32_bf16 v[240:243], v[136:139], v[168:171], v[240:243]
    v_mfma_f32_16x16x32_bf16 v[240:243], v[140:143], v[164:167], v[240:243]
    v_mfma_f32_16x16x32_bf16 v[240:243], v[144:147], v[160:163], v[240:243]
    v_mfma_f32_16x16x32_bf16 v[244:247], v[128:131], v[180:183], v[244:247]
    v_mfma_f32_16x16x32_bf16 v[244:247], v[132:135], v[176:179], v[244:247]
    v_mfma_f32_16x16x32_bf16 v[244:247], v[136:139], v[172:175], v[244:247]
    v_mfma_f32_16x16x32_bf16 v[244:247], v[140:143], v[168:171], v[244:247]
    v_mfma_f32_16x16x32_bf16 v[244:247], v[144:147], v[164:167], v[244:247]
    v_mfma_f32_16x16x32_bf16 v[244:247], v[148:151], v[160:163], v[244:247]
    v_mfma_f32_16x16x32_bf16 v[248:251], v[128:131], v[184:187], v[248:251]
    v_mfma_f32_16x16x32_bf16 v[248:251], v[132:135], v[180:183], v[248:251]
    v_mfma_f32_16x16x32_bf16 v[248:251], v[136:139], v[176:179], v[248:251]
    v_mfma_f32_16x16x32_bf16 v[248:251], v[140:143], v[172:175], v[248:251]
    v_mfma_f32_16x16x32_bf16 v[248:251], v[144:147], v[168:171], v[248:251]
    v_mfma_f32_16x16x32_bf16 v[248:251], v[148:151], v[164:167], v[248:251]
    v_mfma_f32_16x16x32_bf16 v[248:251], v[152:155], v[160:163], v[248:251]
    v_mfma_f32_16x16x32_bf16 v[252:255], v[128:131], v[188:191], v[252:255]
    v_mfma_f32_16x16x32_bf16 v[252:255], v[132:135], v[184:187], v[252:255]
    v_mfma_f32_16x16x32_bf16 v[252:255], v[136:139], v[180:183], v[252:255]
    v_mfma_f32_16x16x32_bf16 v[252:255], v[140:143], v[176:179], v[252:255]
    v_mfma_f32_16x16x32_bf16 v[252:255], v[144:147], v[172:175], v[252:255]
    v_mfma_f32_16x16x32_bf16 v[252:255], v[148:151], v[168:171], v[252:255]
    v_mfma_f32_16x16x32_bf16 v[252:255], v[152:155], v[164:167], v[252:255]
    v_mfma_f32_16x16x32_bf16 v[252:255], v[156:159], v[160:163], v[252:255]
    s_nop 7
    s_add_u32 s54, s28, 21248
    v_add_u32 v9, s54, v1
    s_cmp_eq_u32 s25, 0
    s_cbranch_scc1 CV_X0
    ds_write_b128 v9, v[224:227] offset:0
    ds_write_b128 v9, v[228:231] offset:1024
    ds_write_b128 v9, v[232:235] offset:2048
    ds_write_b128 v9, v[236:239] offset:3072
    s_waitcnt lgkmcnt(0)
    s_barrier
    ds_read_b128 v[64:67], v9 offset:4096
    ds_read_b128 v[68:71], v9 offset:5120
    ds_read_b128 v[72:75], v9 offset:6144
    ds_read_b128 v[76:79], v9 offset:7168
    s_waitcnt lgkmcnt(0)
    v_add_f32 v64, v64, v240
    v_add_f32 v65, v65, v241
    v_add_f32 v66, v66, v242
    v_add_f32 v67, v67, v243
    v_add_f32 v68, v68, v244
    v_add_f32 v69, v69, v245
    v_add_f32 v70, v70, v246
    v_add_f32 v71, v71, v247
    v_add_f32 v72, v72, v248
    v_add_f32 v73, v73, v249
    v_add_f32 v74, v74, v250
    v_add_f32 v75, v75, v251
    v_add_f32 v76, v76, v252
    v_add_f32 v77, v77, v253
    v_add_f32 v78, v78, v254
    v_add_f32 v79, v79, v255
    s_branch CV_FIN
CV_X0:
    ds_write_b128 v9, v[240:243] offset:4096
    ds_write_b128 v9, v[244:247] offset:5120
    ds_write_b128 v9, v[248:251] offset:6144
    ds_write_b128 v9, v[252:255] offset:7168
    s_waitcnt lgkmcnt(0)
    s_barrier
    ds_read_b128 v[64:67], v9 offset:0
    ds_read_b128 v[68:71], v9 offset:1024
    ds_read_b128 v[72:75], v9 offset:2048
    ds_read_b128 v[76:79], v9 offset:3072
    s_waitcnt lgkmcnt(0)
    v_add_f32 v64, v64, v224
    v_add_f32 v65, v65, v225
    v_add_f32 v66, v66, v226
    v_add_f32 v67, v67, v227
    v_add_f32 v68, v68, v228
    v_add_f32 v69, v69, v229
    v_add_f32 v70, v70, v230
    v_add_f32 v71, v71, v231
    v_add_f32 v72, v72, v232
    v_add_f32 v73, v73, v233
    v_add_f32 v74, v74, v234
    v_add_f32 v75, v75, v235
    v_add_f32 v76, v76, v236
    v_add_f32 v77, v77, v237
    v_add_f32 v78, v78, v238
    v_add_f32 v79, v79, v239
CV_FIN:
    v_lshlrev_b32 v10, 4, v4
    v_lshl_add_u32 v10, v5, 2, v10
    s_lshl_b32 s54, s25, 10
    v_add_u32 v10, s54, v10
    s_add_u32 s55, s28, 19192
    v_lshlrev_b32 v11, 1, v10
    v_sub_u32 v11, s55, v11
    ds_read_b64 v[80:81], v11 offset:1536
    ds_read_b64 v[82:83], v11 offset:1024
    ds_read_b64 v[84:85], v11 offset:512
    ds_read_b64 v[86:87], v11 offset:0
    v_lshlrev_b32 v3, 16, v3
    s_mov_b32 s56, 0xffff0000
    v_lshlrev_b32 v12, 1, v10
    v_add_u32 v12, s27, v12
    s_waitcnt lgkmcnt(0)
    v_and_b32 v96, s56, v81
    v_lshlrev_b32 v97, 16, v81
    v_and_b32 v98, s56, v80
    v_lshlrev_b32 v99, 16, v80
    v_mul_f32 v96, v96, v3
    v_mul_f32 v97, v97, v3
    v_mul_f32 v98, v98, v3
    v_mul_f32 v99, v99, v3
    v_cvt_pk_bf16_f32 v100, v96, v97
    v_cvt_pk_bf16_f32 v101, v98, v99
    v_cvt_pk_bf16_f32 v102, v64, v65
    v_cvt_pk_bf16_f32 v103, v66, v67
    v_lshlrev_b32 v96, 16, v100
    v_and_b32 v97, s56, v100
    v_lshlrev_b32 v104, 16, v102
    v_and_b32 v105, s56, v102
    v_lshlrev_b32 v98, 16, v101
    v_and_b32 v99, s56, v101
    v_lshlrev_b32 v106, 16, v103
    v_and_b32 v107, s56, v103
    v_add_f32 v96, v96, v104
    v_add_f32 v97, v97, v105
    v_add_f32 v98, v98, v106
    v_add_f32 v99, v99, v107
    v_cvt_pk_bf16_f32 v108, v96, v97
    v_cvt_pk_bf16_f32 v109, v98, v99
    buffer_store_dwordx2 v[108:109], v12, s[40:43], 0 offen offset:0 sc1
    v_and_b32 v96, s56, v83
    v_lshlrev_b32 v97, 16, v83
    v_and_b32 v98, s56, v82
    v_lshlrev_b32 v99, 16, v82
    v_mul_f32 v96, v96, v3
    v_mul_f32 v97, v97, v3
    v_mul_f32 v98, v98, v3
    v_mul_f32 v99, v99, v3
    v_cvt_pk_bf16_f32 v100, v96, v97
    v_cvt_pk_bf16_f32 v101, v98, v99
    v_cvt_pk_bf16_f32 v102, v68, v69
    v_cvt_pk_bf16_f32 v103, v70, v71
    v_lshlrev_b32 v96, 16, v100
    v_and_b32 v97, s56, v100
    v_lshlrev_b32 v104, 16, v102
    v_and_b32 v105, s56, v102
    v_lshlrev_b32 v98, 16, v101
    v_and_b32 v99, s56, v101
    v_lshlrev_b32 v106, 16, v103
    v_and_b32 v107, s56, v103
    v_add_f32 v96, v96, v104
    v_add_f32 v97, v97, v105
    v_add_f32 v98, v98, v106
    v_add_f32 v99, v99, v107
    v_cvt_pk_bf16_f32 v110, v96, v97
    v_cvt_pk_bf16_f32 v111, v98, v99
    buffer_store_dwordx2 v[110:111], v12, s[40:43], 0 offen offset:512 sc1
    v_and_b32 v96, s56, v85
    v_lshlrev_b32 v97, 16, v85
    v_and_b32 v98, s56, v84
    v_lshlrev_b32 v99, 16, v84
    v_mul_f32 v96, v96, v3
    v_mul_f32 v97, v97, v3
    v_mul_f32 v98, v98, v3
    v_mul_f32 v99, v99, v3
    v_cvt_pk_bf16_f32 v100, v96, v97
    v_cvt_pk_bf16_f32 v101, v98, v99
    v_cvt_pk_bf16_f32 v102, v72, v73
    v_cvt_pk_bf16_f32 v103, v74, v75
    v_lshlrev_b32 v96, 16, v100
    v_and_b32 v97, s56, v100
    v_lshlrev_b32 v104, 16, v102
    v_and_b32 v105, s56, v102
    v_lshlrev_b32 v98, 16, v101
    v_and_b32 v99, s56, v101
    v_lshlrev_b32 v106, 16, v103
    v_and_b32 v107, s56, v103
    v_add_f32 v96, v96, v104
    v_add_f32 v97, v97, v105
    v_add_f32 v98, v98, v106
    v_add_f32 v99, v99, v107
    v_cvt_pk_bf16_f32 v112, v96, v97
    v_cvt_pk_bf16_f32 v113, v98, v99
    buffer_store_dwordx2 v[112:113], v12, s[40:43], 0 offen offset:1024 sc1
    v_and_b32 v96, s56, v87
    v_lshlrev_b32 v97, 16, v87
    v_and_b32 v98, s56, v86
    v_lshlrev_b32 v99, 16, v86
    v_mul_f32 v96, v96, v3
    v_mul_f32 v97, v97, v3
    v_mul_f32 v98, v98, v3
    v_mul_f32 v99, v99, v3
    v_cvt_pk_bf16_f32 v100, v96, v97
    v_cvt_pk_bf16_f32 v101, v98, v99
    v_cvt_pk_bf16_f32 v102, v76, v77
    v_cvt_pk_bf16_f32 v103, v78, v79
    v_lshlrev_b32 v96, 16, v100
    v_and_b32 v97, s56, v100
    v_lshlrev_b32 v104, 16, v102
    v_and_b32 v105, s56, v102
    v_lshlrev_b32 v98, 16, v101
    v_and_b32 v99, s56, v101
    v_lshlrev_b32 v106, 16, v103
    v_and_b32 v107, s56, v103
    v_add_f32 v96, v96, v104
    v_add_f32 v97, v97, v105
    v_add_f32 v98, v98, v106
    v_add_f32 v99, v99, v107
    v_cvt_pk_bf16_f32 v114, v96, v97
    v_cvt_pk_bf16_f32 v115, v98, v99
    buffer_store_dwordx2 v[114:115], v12, s[40:43], 0 offen offset:1536 sc1
    s_waitcnt vmcnt(0)
    s_barrier
    s_cmp_lg_u32 s20, 0
    s_cbranch_scc1 F_END
    s_and_b32 s54, s2, 7
    s_lshl_b32 s54, s54, 5
    s_lshr_b32 s55, s2, 3
    s_add_u32 s54, s54, s55
    s_lshl_b32 s54, s54, 7
    s_add_u32 s54, s54, 65536
    v_mov_b32 v1, s54
    s_mov_b64 exec, 1
    buffer_store_dwordx2 v[14:15], v1, s[60:63], 0 offen sc1
    s_endpgm
F_END:
    s_endpgm
.section .rodata,"a"
.p2align 6
.amdhsa_kernel fused_kernel
  .amdhsa_next_free_vgpr 256
  .amdhsa_next_free_sgpr 102
  .amdhsa_accum_offset 256
  .amdhsa_group_segment_fixed_size 0
  .amdhsa_kernarg_size 104
  .amdhsa_user_sgpr_count 2
  .amdhsa_user_sgpr_kernarg_segment_ptr 1
  .amdhsa_system_sgpr_workgroup_id_x 1
.end_amdhsa_kernel
```
